```python
import torch

def _softmax(x, axis=-1):
    return torch.softmax(x, dim=axis)
def _gelu(x):
    return torch.nn.functional.gelu(x, approximate="tanh")
def _silu(x):
    return torch.nn.functional.silu(x)
def _sigmoid(x):
    return torch.sigmoid(x)
def _layernorm(x, axis=-1, eps=1e-5):
    m = x.mean(dim=axis, keepdim=True)
    v = x.var(dim=axis, keepdim=True, unbiased=False)
    return (x - m) / torch.sqrt(v + eps)
def _scatter_add(tgt, idx, src, axis=0):
    return tgt.clone().index_add_(axis, idx, src)
def _segment_sum(src, seg, n):
    out = torch.zeros((n,) + src.shape[1:], dtype=src.dtype)
    return out.index_add_(0, seg, src)
def _pad(x, pw):
    flat = tuple(v for pair in reversed(pw) for v in pair)
    return torch.nn.functional.pad(x, flat)

kernel_name = 'sequential_preLN__gqa_block_cached__mixer_channel_mlp__decode'

def setup_inputs():

    _w = (lambda a: (lambda t: t.to(torch.bfloat16) if t.is_floating_point() else t)(torch.as_tensor(a)))
    def _A_setup():
        B, Sq, D = 4, 1, 512
        Hq, Hkv, Sk, Dh = 32, 8, 4096, 128
        assert Hq % Hkv == 0, (Hq, Hkv)
        return {
            "x": _w((lambda *s: torch.randn(*s, dtype=torch.bfloat16) * 0.05)(B, Sq, D)),
            "k_cache": _w((lambda *s: torch.randn(*s, dtype=torch.bfloat16) * 3.2)(B, Hkv, Sk, Dh)),
            "v_cache": _w((lambda *s: torch.randn(*s, dtype=torch.bfloat16) * 0.4)(B, Hkv, Sk, Dh)),
            "wq": _w((lambda *s: torch.randn(*s, dtype=torch.bfloat16) * 3.2)(D, Hq * Dh) * (D ** -0.5)),
            "wo": _w((lambda *s: torch.randn(*s, dtype=torch.bfloat16) * 0.4)(Hq * Dh, D) * ((Hq * Dh) ** -0.5)),
        }
    _A_in = _A_setup()

    def _B_setup():
        B, S, D, F = 4, 1, 512, 1792
        return {
            "x": _w((lambda *s: torch.randn(*s, dtype=torch.bfloat16) * 0.05)(B, S, D)),
            "w1": _w((lambda *s: torch.randn(*s, dtype=torch.bfloat16) * 3.2)(D, F) * (D ** -0.5)),
            "b1": _w((lambda *s: torch.randn(*s, dtype=torch.bfloat16) * 3.2)(F)),
            "w2": _w((lambda *s: torch.randn(*s, dtype=torch.bfloat16) * 0.4)(F, D) * (F ** -0.5)),
            "b2": _w((lambda *s: torch.randn(*s, dtype=torch.bfloat16) * 0.8)(D)),
        }
    _B_in = _B_setup()

    return {
        "A_x": _A_in["x"],
        "A_k_cache": _A_in["k_cache"],
        "A_v_cache": _A_in["v_cache"],
        "A_wq": _A_in["wq"],
        "A_wo": _A_in["wo"],
        "B_x": _B_in["x"],
        "B_w1": _B_in["w1"],
        "B_b1": _B_in["b1"],
        "B_w2": _B_in["w2"],
        "B_b2": _B_in["b2"],
    }

def reference(A_x, A_k_cache, A_v_cache, A_wq, A_wo, B_x, B_w1, B_b1, B_w2, B_b2):
    def _A_ref(x, k_cache, v_cache, wq, wo):
        B, Sq, D = x.shape
        Hq, Dh = 32, 128
        Hkv = k_cache.shape[1]
        rep = Hq // Hkv
        q = (lambda x, *d: x.permute(*d))((x @ wq).reshape(B, Sq, Hq, Dh), 0, 2, 1, 3)
        k = (lambda x, n, axis: torch.repeat_interleave(x, n, dim=axis))(k_cache, rep, axis=1)
        v = (lambda x, n, axis: torch.repeat_interleave(x, n, dim=axis))(v_cache, rep, axis=1)
        scores = torch.einsum("bhqd,bhkd->bhqk", q, k) * (Dh ** -0.5)
        p = _softmax(scores, axis=-1)
        o = torch.einsum("bhqk,bhkd->bhqd", p, v)
        return (lambda x, *d: x.permute(*d))(o, 0, 2, 1, 3).reshape(B, Sq, Hq * Dh) @ wo

    def _B_ref(x, w1, b1, w2, b2):
        y = _layernorm(x, axis=-1)
        h = _gelu(torch.einsum("bsd,df->bsf", y, w1) + b1)
        return torch.einsum("bsf,fd->bsd", h, w2) + b2

    x = A_x
    h = x + _A_ref(_layernorm(x, axis=-1), A_k_cache, A_v_cache, A_wq, A_wo)
    h2 = h + _B_ref(_layernorm(h, axis=-1), B_w1, B_b1, B_w2, B_b2)
    return h2
```

```asm
; @launch grid=(256,1,1) block=(512,1,1) lds=122880
.amdgcn_target "amdgcn-amd-amdhsa--gfx950"
.text
.globl sequential_preLN__gqa_block_cached__mixer_channel_mlp__decode_kernel
.p2align 8
.type sequential_preLN__gqa_block_cached__mixer_channel_mlp__decode_kernel,@function
sequential_preLN__gqa_block_cached__mixer_channel_mlp__decode_kernel:
    s_load_dwordx2 s[56:57], s[0:1], 96
    s_load_dwordx2 s[20:21], s[0:1], 8
    s_load_dwordx2 s[16:17], s[0:1], 0
    s_load_dwordx2 s[28:29], s[0:1], 24
    s_load_dwordx2 s[24:25], s[0:1], 16
    s_load_dwordx2 s[32:33], s[0:1], 32
    s_load_dwordx2 s[36:37], s[0:1], 48
    s_load_dwordx2 s[40:41], s[0:1], 56
    s_load_dwordx2 s[44:45], s[0:1], 64
    s_load_dwordx2 s[48:49], s[0:1], 72
    s_load_dwordx2 s[52:53], s[0:1], 80
    s_cmp_ge_u32 s2, 256
    s_cbranch_scc1 L_end
    v_lshrrev_b32 v4, 6, v0
    v_and_b32 v1, 63, v0
    v_readfirstlane_b32 s3, v4
    v_and_b32 v2, 15, v1
    v_lshrrev_b32 v3, 4, v1
    s_and_b32 s4, s2, 7
    s_lshr_b32 s7, s2, 3
    s_lshr_b32 s5, s7, 3
    s_and_b32 s6, s7, 7
    s_mov_b32 s58, 268435456
    s_mov_b32 s59, 0x20000
    s_mov_b32 s22, 33554432
    s_mov_b32 s23, 0x20000
    s_mov_b32 s18, 4096
    s_mov_b32 s19, 0x20000
    s_mov_b32 s30, 4194304
    s_mov_b32 s31, 0x20000
    s_and_b32 s11, s3, 3
    s_lshl_b32 s70, s5, 3
    s_add_u32 s70, s70, s4
    s_lshl_b32 s64, s70, 20
    s_lshl_b32 s10, s6, 17
    s_add_u32 s64, s64, s10
    s_lshl_b32 s10, s11, 15
    s_add_u32 s64, s64, s10
    s_lshl_b32 s83, s5, 13
    s_add_u32 s65, s64, s83
    v_mov_b32 v6, 0
    v_lshlrev_b32 v14, 4, v1
    s_cmp_ge_u32 s3, 4
    s_cbranch_scc1 L_v1
    v_lshlrev_b32 v47, 8, v2
    v_lshlrev_b32 v10, 4, v3
    v_add_u32 v47, v47, v10
    s_lshl_b32 s10, s4, 2
    s_add_u32 s10, s10, s5
    s_lshl_b32 s10, s10, 14
    s_lshl_b32 s12, s11, 10
    s_add_u32 s10, s10, s12
    s_add_u32 s66, s10, 1081344
    s_add_u32 s72, s66, 4096
    s_add_u32 s73, s66, 8192
    s_add_u32 s74, s66, 12288
    s_setprio 2
    s_waitcnt lgkmcnt(0)
    buffer_load_dwordx4 v[64:67], v47, s[20:23], s65 offen offset:0 nt
    buffer_load_dwordx4 v[68:71], v47, s[20:23], s65 offen offset:64 nt
    buffer_load_dwordx4 v[72:75], v47, s[20:23], s65 offen offset:128 nt
    buffer_load_dwordx4 v[76:79], v47, s[20:23], s65 offen offset:192 nt
    s_add_u32 s83, s83, 4096
    s_and_b32 s83, s83, 0x7fff
    s_add_u32 s65, s64, s83
    buffer_load_dwordx4 v[80:83], v47, s[20:23], s65 offen offset:0 nt
    buffer_load_dwordx4 v[84:87], v47, s[20:23], s65 offen offset:64 nt
    buffer_load_dwordx4 v[88:91], v47, s[20:23], s65 offen offset:128 nt
    buffer_load_dwordx4 v[92:95], v47, s[20:23], s65 offen offset:192 nt
    s_add_u32 s83, s83, 4096
    s_and_b32 s83, s83, 0x7fff
    s_add_u32 s65, s64, s83
    buffer_load_dword v5, v6, s[56:59], 0 offen sc1
    v_lshlrev_b32 v9, 2, v1
    v_add_u32 v9, 117760, v9
    ds_write_b32 v9, v6
    v_mov_b32 v0, 1
    s_waitcnt lgkmcnt(0)
    s_barrier
    buffer_load_dwordx4 v[96:99], v47, s[20:23], s65 offen offset:0 nt
    buffer_load_dwordx4 v[100:103], v47, s[20:23], s65 offen offset:64 nt
    buffer_load_dwordx4 v[104:107], v47, s[20:23], s65 offen offset:128 nt
    buffer_load_dwordx4 v[108:111], v47, s[20:23], s65 offen offset:192 nt
    s_add_u32 s83, s83, 4096
    s_and_b32 s83, s83, 0x7fff
    s_add_u32 s65, s64, s83
    buffer_load_dwordx4 v[112:115], v47, s[20:23], s65 offen offset:0 nt
    buffer_load_dwordx4 v[116:119], v47, s[20:23], s65 offen offset:64 nt
    buffer_load_dwordx4 v[120:123], v47, s[20:23], s65 offen offset:128 nt
    buffer_load_dwordx4 v[124:127], v47, s[20:23], s65 offen offset:192 nt
    s_add_u32 s83, s83, 4096
    s_and_b32 s83, s83, 0x7fff
    s_add_u32 s65, s64, s83
    buffer_load_dwordx4 v[128:131], v47, s[20:23], s65 offen offset:0 nt
    buffer_load_dwordx4 v[132:135], v47, s[20:23], s65 offen offset:64 nt
    buffer_load_dwordx4 v[136:139], v47, s[20:23], s65 offen offset:128 nt
    buffer_load_dwordx4 v[140:143], v47, s[20:23], s65 offen offset:192 nt
    s_add_u32 s83, s83, 4096
    s_and_b32 s83, s83, 0x7fff
    s_add_u32 s65, s64, s83
    buffer_load_dwordx4 v[144:147], v47, s[20:23], s65 offen offset:0 nt
    buffer_load_dwordx4 v[148:151], v47, s[20:23], s65 offen offset:64 nt
    buffer_load_dwordx4 v[152:155], v47, s[20:23], s65 offen offset:128 nt
    buffer_load_dwordx4 v[156:159], v47, s[20:23], s65 offen offset:192 nt
    s_add_u32 s83, s83, 4096
    s_and_b32 s83, s83, 0x7fff
    s_add_u32 s65, s64, s83
    buffer_load_dwordx4 v[16:19], v14, s[56:59], s66 offen sc1
    buffer_load_dwordx4 v[20:23], v14, s[56:59], s72 offen sc1
    buffer_load_dwordx4 v[24:27], v14, s[56:59], s73 offen sc1
    buffer_load_dwordx4 v[28:31], v14, s[56:59], s74 offen sc1
    buffer_load_dwordx4 v[160:163], v47, s[20:23], s65 offen offset:0 nt
    buffer_load_dwordx4 v[164:167], v47, s[20:23], s65 offen offset:64 nt
    buffer_load_dwordx4 v[168:171], v47, s[20:23], s65 offen offset:128 nt
    buffer_load_dwordx4 v[172:175], v47, s[20:23], s65 offen offset:192 nt
    s_add_u32 s83, s83, 4096
    s_and_b32 s83, s83, 0x7fff
    s_add_u32 s65, s64, s83
    buffer_load_dwordx4 v[176:179], v47, s[20:23], s65 offen offset:0 nt
    buffer_load_dwordx4 v[180:183], v47, s[20:23], s65 offen offset:64 nt
    buffer_load_dwordx4 v[184:187], v47, s[20:23], s65 offen offset:128 nt
    buffer_load_dwordx4 v[188:191], v47, s[20:23], s65 offen offset:192 nt
    s_branch L_k2
L_v1:
    v_lshrrev_b32 v10, 3, v1
    v_lshlrev_b32 v10, 13, v10
    v_and_b32 v9, 7, v1
    v_lshlrev_b32 v9, 4, v9
    v_add_u32 v10, v10, v9
    s_lshl_b32 s13, s5, 20
    s_lshl_b32 s12, s11, 18
    s_add_u32 s13, s13, s12
    s_lshl_b32 s12, s4, 10
    s_add_u32 s13, s13, s12
    s_lshl_b32 s12, s6, 7
    s_add_u32 s13, s13, s12
    s_lshl_b32 s12, s11, 12
    s_add_u32 s12, s12, 65536
    s_lshl_b32 s10, s11, 10
    s_setprio 3
    s_waitcnt lgkmcnt(0)
    buffer_load_dwordx4 v[16:19], v14, s[16:19], s10 offen
    s_mov_b32 s14, s13
    s_mov_b32 m0, s12
    s_add_u32 s12, s12, 1024
    buffer_load_dwordx4 v10, s[28:31], s13 offen nt lds
    s_add_u32 s13, s13, 0x10000
    s_mov_b32 m0, s12
    s_add_u32 s12, s12, 1024
    buffer_load_dwordx4 v10, s[28:31], s13 offen nt lds
    s_add_u32 s13, s13, 0x10000
    s_mov_b32 m0, s12
    s_add_u32 s12, s12, 1024
    buffer_load_dwordx4 v10, s[28:31], s13 offen nt lds
    s_add_u32 s13, s13, 0x10000
    s_mov_b32 m0, s12
    s_add_u32 s12, s12, 1024
    buffer_load_dwordx4 v10, s[28:31], s13 offen nt lds
    s_add_u32 s13, s13, 0x10000
    buffer_load_dword v5, v6, s[56:59], 0 offen sc1
    v_lshlrev_b32 v9, 2, v1
    v_add_u32 v9, 117760, v9
    ds_write_b32 v9, v6
    v_mov_b32 v0, 1
    s_waitcnt lgkmcnt(0)
    s_barrier
    s_mov_b32 s26, 33554432
    s_mov_b32 s27, 0x20000
    s_mov_b32 s26, 33554432
    s_mov_b32 s27, 0x20000
    s_mov_b32 s34, 4194304
    s_mov_b32 s35, 0x20000
    s_mov_b32 s38, 1835008
    s_mov_b32 s39, 0x20000
    s_mov_b32 s42, 3584
    s_mov_b32 s43, 0x20000
    s_mov_b32 s46, 1835008
    s_mov_b32 s47, 0x20000
    s_mov_b32 s50, 1024
    s_mov_b32 s51, 0x20000
    s_mov_b32 s54, 4096
    s_mov_b32 s55, 0x20000
    s_lshl_b32 s87, s4, 3
    s_mov_b32 s98, 336860180
    s_mov_b32 s99, 168561678
    s_lshr_b64 s[98:99], s[98:99], s87
    s_and_b32 s10, s98, 0xff
    s_mov_b32 s98, 117901063
    s_mov_b32 s99, 117901063
    s_lshr_b64 s[98:99], s[98:99], s87
    s_and_b32 s12, s98, 0xff
    s_mov_b32 s98, 84215045
    s_mov_b32 s99, 185273099
    s_lshr_b64 s[98:99], s[98:99], s87
    s_and_b32 s13, s98, 0xff
    s_mov_b32 s98, 1009259520
    s_mov_b32 s99, 1986682448
    s_lshr_b64 s[98:99], s[98:99], s87
    s_and_b32 s14, s98, 0xff
    s_add_u32 s15, s14, s7
    s_mov_b32 s98, 353240832
    s_mov_b32 s99, 824845084
    s_lshr_b64 s[98:99], s[98:99], s87
    s_and_b32 s14, s98, 0xff
    s_sub_u32 s10, s7, s10
    s_add_u32 s9, s14, s10
    s_mov_b32 s97, 3
    s_sub_u32 s76, s10, s12
    s_cmp_lt_u32 s76, s13
    s_cselect_b32 s97, 2, s97
    s_cmp_lt_u32 s10, s12
    s_cselect_b32 s97, 1, s97
    s_cmp_gt_u32 s10, s7
    s_cselect_b32 s97, 0, s97
    s_mov_b32 s98, 252314880
    s_mov_b32 s99, 891952916
    s_lshr_b64 s[98:99], s[98:99], s87
    s_and_b32 s14, s98, 0xff
    s_add_u32 s13, s14, s76
    s_lshr_b32 s84, s15, 4
    s_and_b32 s84, s84, 7
    s_lshr_b32 s85, s15, 2
    s_and_b32 s85, s85, 3
    s_and_b32 s86, s15, 3
    s_lshr_b32 s76, s13, 4
    s_and_b32 s76, s76, 3
    s_and_b32 s10, s13, 15
    s_lshl_b32 s62, s10, 5
    s_mov_b32 s60, 0x05040100
    s_mov_b32 s61, 0x07060302
    s_mov_b32 s63, 0xffff0000
    v_mov_b32 v7, 117760
    s_lshl_b32 s10, s11, 2
    v_add_u32 v11, s10, v7
    v_lshlrev_b32 v13, 3, v1
    v_lshrrev_b32 v9, 2, v2
    v_lshlrev_b32 v10, 3, v3
    v_add_u32 v9, v9, v10
    v_lshlrev_b32 v44, 7, v9
    v_and_b32 v10, 3, v2
    v_lshlrev_b32 v10, 3, v10
    v_add_u32 v44, v44, v10
    s_lshl_b32 s10, s11, 12
    s_add_u32 s10, s10, 65536
    v_add_u32 v44, s10, v44
    v_mov_b32 v48, v44
    v_and_b32 v45, 3, v2
    v_lshlrev_b32 v45, 10, v45
    v_lshlrev_b32 v46, 4, v3
    v_add_u32 v45, v45, v46
    s_lshl_b32 s10, s5, 8
    s_lshl_b32 s12, s11, 6
    s_add_u32 s10, s10, s12
    s_add_u32 s10, s10, 98304
    v_add_u32 v45, s10, v45
    v_lshlrev_b32 v46, 4, v2
    s_lshl_b32 s10, s11, 10
    s_add_u32 s10, s10, 102400
    v_add_u32 v46, s10, v46
    s_lshl_b32 s10, s11, 2
    s_add_u32 s10, s10, 102400
    v_add_u32 v47, s10, v14
    s_lshl_b32 s10, s11, 10
    s_add_u32 s10, s10, 98304
    v_add_u32 v9, s10, v14
    s_lshl_b32 s10, s4, 2
    s_add_u32 s10, s10, s11
    s_lshl_b32 s10, s10, 2
    s_add_u32 s10, s10, s5
    s_lshl_b32 s10, s10, 12
    s_lshl_b32 s12, s6, 9
    s_add_u32 s10, s10, s12
    s_add_u32 s66, s10, 1081344
    s_waitcnt vmcnt(5)
    v_lshlrev_b32 v20, 16, v16
    v_and_b32 v21, s63, v16
    v_lshlrev_b32 v22, 16, v17
    v_and_b32 v23, s63, v17
    v_lshlrev_b32 v24, 16, v18
    v_and_b32 v25, s63, v18
    v_lshlrev_b32 v26, 16, v19
    v_and_b32 v27, s63, v19
    v_readfirstlane_b32 s12, v20
    s_nop 1
    v_subrev_f32 v34, s12, v20
    v_subrev_f32 v35, s12, v21
    v_add_f32 v32, v34, v35
    v_mul_f32 v33, v34, v34
    v_fmac_f32 v33, v35, v35
    v_subrev_f32 v34, s12, v22
    v_subrev_f32 v35, s12, v23
    v_add_f32 v32, v32, v34
    v_fmac_f32 v33, v34, v34
    v_add_f32 v32, v32, v35
    v_fmac_f32 v33, v35, v35
    v_subrev_f32 v34, s12, v24
    v_subrev_f32 v35, s12, v25
    v_add_f32 v32, v32, v34
    v_fmac_f32 v33, v34, v34
    v_add_f32 v32, v32, v35
    v_fmac_f32 v33, v35, v35
    v_subrev_f32 v34, s12, v26
    v_subrev_f32 v35, s12, v27
    v_add_f32 v32, v32, v34
    v_fmac_f32 v33, v34, v34
    v_add_f32 v32, v32, v35
    v_fmac_f32 v33, v35, v35
    s_nop 0
    v_add_f32_dpp v32, v32, v32 row_ror:8 row_mask:0xf bank_mask:0xf
    v_add_f32_dpp v33, v33, v33 row_ror:8 row_mask:0xf bank_mask:0xf
    s_nop 0
    v_add_f32_dpp v32, v32, v32 row_ror:4 row_mask:0xf bank_mask:0xf
    v_add_f32_dpp v33, v33, v33 row_ror:4 row_mask:0xf bank_mask:0xf
    s_nop 0
    v_add_f32_dpp v32, v32, v32 row_ror:2 row_mask:0xf bank_mask:0xf
    v_add_f32_dpp v33, v33, v33 row_ror:2 row_mask:0xf bank_mask:0xf
    s_nop 0
    v_add_f32_dpp v32, v32, v32 row_ror:1 row_mask:0xf bank_mask:0xf
    v_add_f32_dpp v33, v33, v33 row_ror:1 row_mask:0xf bank_mask:0xf
    v_mov_b32 v34, v32
    v_mov_b32 v35, v33
    s_nop 0
    v_permlane16_swap_b32 v32, v34
    v_permlane16_swap_b32 v33, v35
    v_add_f32 v32, v32, v34
    v_add_f32 v33, v33, v35
    v_mov_b32 v34, v32
    v_mov_b32 v35, v33
    s_nop 0
    v_permlane32_swap_b32 v32, v34
    v_permlane32_swap_b32 v33, v35
    v_add_f32 v32, v32, v34
    v_add_f32 v33, v33, v35
    v_mul_f32 v32, 0x3b000000, v32
    v_mul_f32 v33, 0x3b000000, v33
    v_fma_f32 v33, -v32, v32, v33
    v_add_f32 v32, s12, v32
    v_max_f32 v33, 0, v33
    v_cvt_pk_bf16_f32 v34, v32, v33
    v_and_b32 v33, s63, v34
    v_lshlrev_b32 v32, 16, v34
    v_add_f32 v33, 925353388, v33
    v_sub_f32 v20, v20, v32
    v_sub_f32 v21, v21, v32
    v_sub_f32 v22, v22, v32
    v_sub_f32 v23, v23, v32
    v_cvt_pk_bf16_f32 v33, v33, v33
    v_lshlrev_b32 v33, 16, v33
    v_sqrt_f32 v33, v33
    v_sub_f32 v24, v24, v32
    v_sub_f32 v25, v25, v32
    v_sub_f32 v26, v26, v32
    v_sub_f32 v27, v27, v32
    v_cvt_pk_bf16_f32 v33, v33, v33
    v_lshlrev_b32 v33, 16, v33
    v_rcp_f32 v33, v33
    v_cvt_pk_bf16_f32 v40, v20, v21
    v_cvt_pk_bf16_f32 v41, v22, v23
    v_cvt_pk_bf16_f32 v42, v24, v25
    v_cvt_pk_bf16_f32 v43, v26, v27
    v_lshlrev_b32 v20, 16, v40
    v_and_b32 v21, s63, v40
    v_lshlrev_b32 v22, 16, v41
    v_and_b32 v23, s63, v41
    v_lshlrev_b32 v24, 16, v42
    v_and_b32 v25, s63, v42
    v_lshlrev_b32 v26, 16, v43
    v_and_b32 v27, s63, v43
    v_mul_f32 v20, v20, v33
    v_mul_f32 v21, v21, v33
    v_mul_f32 v22, v22, v33
    v_mul_f32 v23, v23, v33
    v_mul_f32 v24, v24, v33
    v_mul_f32 v25, v25, v33
    v_mul_f32 v26, v26, v33
    v_mul_f32 v27, v27, v33
    v_cvt_pk_bf16_f32 v40, v20, v21
    v_cvt_pk_bf16_f32 v41, v22, v23
    v_cvt_pk_bf16_f32 v42, v24, v25
    v_cvt_pk_bf16_f32 v43, v26, v27
    ds_write_b128 v9, v[40:43]
    ds_write_b32 v11, v0 offset:0
L_wf_1:
    ds_read_b128 v[40:43], v7 offset:0
    s_waitcnt lgkmcnt(0)
    v_and_b32 v40, v40, v41
    v_and_b32 v42, v42, v43
    v_and_b32 v40, v40, v42
    v_cmp_ne_u32 vcc, 1, v40
    s_cbranch_vccnz L_wf_1
    ds_read_b128 v[192:195], v45
    s_waitcnt vmcnt(0)
    v_readfirstlane_b32 s8, v5
    s_nop 1
    s_add_u32 s8, s8, 2654435769
    v_mov_b32 v15, s8
    ds_read_b64_tr_b16 v[196:197], v44 offset:0
    ds_read_b64_tr_b16 v[198:199], v44 offset:512
    ds_read_b64_tr_b16 v[200:201], v44 offset:32
    ds_read_b64_tr_b16 v[202:203], v44 offset:544
    ds_read_b64_tr_b16 v[204:205], v44 offset:64
    ds_read_b64_tr_b16 v[206:207], v44 offset:576
    ds_read_b64_tr_b16 v[208:209], v44 offset:96
    ds_read_b64_tr_b16 v[210:211], v44 offset:608
    s_waitcnt lgkmcnt(0)
    v_mfma_f32_16x16x32_bf16 v[212:215], v[192:195], v[196:199], 0
    v_mfma_f32_16x16x32_bf16 v[216:219], v[192:195], v[200:203], 0
    v_mfma_f32_16x16x32_bf16 v[220:223], v[192:195], v[204:207], 0
    v_mfma_f32_16x16x32_bf16 v[224:227], v[192:195], v[208:211], 0
    v_mov_b32 v45, s8
    s_nop 3
    ds_write_b128 v46, v[212:215] offset:0
    ds_write_b128 v46, v[216:219] offset:256
    ds_write_b128 v46, v[220:223] offset:512
    ds_write_b128 v46, v[224:227] offset:768
    ds_write_b32 v11, v0 offset:16
L_wf_2:
    ds_read_b128 v[40:43], v7 offset:16
    s_waitcnt lgkmcnt(0)
    v_and_b32 v40, v40, v41
    v_and_b32 v42, v42, v43
    v_and_b32 v40, v40, v42
    v_cmp_ne_u32 vcc, 1, v40
    s_cbranch_vccnz L_wf_2
    ds_read_b32 v40, v47 offset:0
    ds_read_b32 v41, v47 offset:1024
    ds_read_b32 v42, v47 offset:2048
    ds_read_b32 v43, v47 offset:3072
    s_waitcnt lgkmcnt(0)
    v_add_f32 v40, v40, v41
    v_add_f32 v42, v42, v43
    v_add_f32 v44, v40, v42
    buffer_store_dwordx2 v[44:45], v13, s[56:59], s66 offen sc1
    s_setprio 1
    buffer_load_dwordx4 v[64:67], v14, s[24:27], s65 offen offset:0 nt
    buffer_load_dwordx4 v[68:71], v14, s[24:27], s65 offen offset:1024 nt
    buffer_load_dwordx4 v[72:75], v14, s[24:27], s65 offen offset:2048 nt
    buffer_load_dwordx4 v[76:79], v14, s[24:27], s65 offen offset:3072 nt
    s_add_u32 s83, s83, 4096
    s_and_b32 s83, s83, 0x7fff
    s_add_u32 s65, s64, s83
    buffer_load_dwordx4 v[80:83], v14, s[24:27], s65 offen offset:0 nt
    buffer_load_dwordx4 v[84:87], v14, s[24:27], s65 offen offset:1024 nt
    buffer_load_dwordx4 v[88:91], v14, s[24:27], s65 offen offset:2048 nt
    buffer_load_dwordx4 v[92:95], v14, s[24:27], s65 offen offset:3072 nt
    s_add_u32 s83, s83, 4096
    s_and_b32 s83, s83, 0x7fff
    s_add_u32 s65, s64, s83
    buffer_load_dwordx4 v[96:99], v14, s[24:27], s65 offen offset:0 nt
    buffer_load_dwordx4 v[100:103], v14, s[24:27], s65 offen offset:1024 nt
    buffer_load_dwordx4 v[104:107], v14, s[24:27], s65 offen offset:2048 nt
    buffer_load_dwordx4 v[108:111], v14, s[24:27], s65 offen offset:3072 nt
    s_add_u32 s83, s83, 4096
    s_and_b32 s83, s83, 0x7fff
    s_add_u32 s65, s64, s83
    buffer_load_dwordx4 v[112:115], v14, s[24:27], s65 offen offset:0 nt
    buffer_load_dwordx4 v[116:119], v14, s[24:27], s65 offen offset:1024 nt
    buffer_load_dwordx4 v[120:123], v14, s[24:27], s65 offen offset:2048 nt
    buffer_load_dwordx4 v[124:127], v14, s[24:27], s65 offen offset:3072 nt
    s_add_u32 s83, s83, 4096
    s_and_b32 s83, s83, 0x7fff
    s_add_u32 s65, s64, s83
    buffer_load_dwordx4 v[128:131], v14, s[24:27], s65 offen offset:0 nt
    buffer_load_dwordx4 v[132:135], v14, s[24:27], s65 offen offset:1024 nt
    buffer_load_dwordx4 v[136:139], v14, s[24:27], s65 offen offset:2048 nt
    buffer_load_dwordx4 v[140:143], v14, s[24:27], s65 offen offset:3072 nt
    s_add_u32 s83, s83, 4096
    s_and_b32 s83, s83, 0x7fff
    s_add_u32 s65, s64, s83
    buffer_load_dwordx4 v[144:147], v14, s[24:27], s65 offen offset:0 nt
    buffer_load_dwordx4 v[148:151], v14, s[24:27], s65 offen offset:1024 nt
    buffer_load_dwordx4 v[152:155], v14, s[24:27], s65 offen offset:2048 nt
    buffer_load_dwordx4 v[156:159], v14, s[24:27], s65 offen offset:3072 nt
    s_add_u32 s83, s83, 4096
    s_and_b32 s83, s83, 0x7fff
    s_add_u32 s65, s64, s83
    buffer_load_dwordx4 v[160:163], v14, s[24:27], s65 offen offset:0 nt
    buffer_load_dwordx4 v[164:167], v14, s[24:27], s65 offen offset:1024 nt
    buffer_load_dwordx4 v[168:171], v14, s[24:27], s65 offen offset:2048 nt
    buffer_load_dwordx4 v[172:175], v14, s[24:27], s65 offen offset:3072 nt
    s_add_u32 s83, s83, 4096
    s_and_b32 s83, s83, 0x7fff
    s_add_u32 s65, s64, s83
    buffer_load_dwordx4 v[176:179], v14, s[24:27], s65 offen offset:0 nt
    buffer_load_dwordx4 v[180:183], v14, s[24:27], s65 offen offset:1024 nt
    buffer_load_dwordx4 v[184:187], v14, s[24:27], s65 offen offset:2048 nt
    buffer_load_dwordx4 v[188:191], v14, s[24:27], s65 offen offset:3072 nt
    ds_write_b32 v11, v0 offset:144
    v_lshlrev_b32 v10, 2, v2
    s_lshl_b32 s10, s76, 10
    s_lshl_b32 s12, s62, 1
    s_add_u32 s10, s10, s12
    buffer_load_dword v12, v10, s[16:19], s10 offen
    s_lshl_b32 s95, s4, 3
    s_add_u32 s95, s95, s6
    s_lshl_b32 s95, s95, 3
    v_and_b32 v9, 3, v1
    v_lshlrev_b32 v9, 2, v9
    s_lshl_b32 s12, s95, 1
    buffer_load_dword v8, v9, s[48:51], s12 offen
    buffer_load_dword v4, v9, s[52:55], s12 offen
    v_lshlrev_b32 v20, 9, v3
    v_lshlrev_b32 v9, 5, v2
    v_add_u32 v20, v20, v9
    s_lshl_b32 s10, s11, 11
    s_add_u32 s10, s10, 81920
    v_add_u32 v20, s10, v20
    s_lshl_b32 s10, s11, 9
    s_add_u32 s10, s10, 81920
    v_add_u32 v21, s10, v13
    s_lshl_b32 s10, s70, 3
    s_add_u32 s10, s10, s6
    s_lshl_b32 s10, s10, 11
    s_lshl_b32 s12, s11, 9
    s_add_u32 s10, s10, s12
    s_add_u32 s66, s10, 32768
    v_lshrrev_b32 v10, 2, v2
    v_lshlrev_b32 v10, 6, v10
    v_lshlrev_b32 v9, 4, v3
    v_add_u32 v10, v10, v9
    s_lshl_b32 s10, s11, 10
    s_add_u32 s10, s10, 106496
    v_add_u32 v10, s10, v10
L_wf_3:
    s_sleep 1
    ds_read_b32 v40, v11 offset:64
    s_waitcnt lgkmcnt(0)
    v_cmp_ne_u32 vcc, 1, v40
    s_cbranch_vccnz L_wf_3
    ds_read_b128 v[224:227], v10 offset:0
    ds_read_b128 v[228:231], v10 offset:256
    ds_read_b128 v[232:235], v10 offset:512
    ds_read_b128 v[236:239], v10 offset:768
    s_waitcnt vmcnt(27)
    v_perm_b32 v192, v68, v64, s60
    v_perm_b32 v196, v68, v64, s61
    v_perm_b32 v200, v69, v65, s60
    v_perm_b32 v204, v69, v65, s61
    v_perm_b32 v208, v70, v66, s60
    v_perm_b32 v212, v70, v66, s61
    v_perm_b32 v216, v71, v67, s60
    v_perm_b32 v220, v71, v67, s61
    v_perm_b32 v193, v76, v72, s60
    v_perm_b32 v197, v76, v72, s61
    v_perm_b32 v201, v77, v73, s60
    v_perm_b32 v205, v77, v73, s61
    v_perm_b32 v209, v78, v74, s60
    v_perm_b32 v213, v78, v74, s61
    v_perm_b32 v217, v79, v75, s60
    v_perm_b32 v221, v79, v75, s61
    v_perm_b32 v194, v84, v80, s60
    v_perm_b32 v198, v84, v80, s61
    v_perm_b32 v202, v85, v81, s60
    v_perm_b32 v206, v85, v81, s61
    v_perm_b32 v210, v86, v82, s60
    v_perm_b32 v214, v86, v82, s61
    v_perm_b32 v218, v87, v83, s60
    v_perm_b32 v222, v87, v83, s61
    v_perm_b32 v195, v92, v88, s60
    v_perm_b32 v199, v92, v88, s61
    v_perm_b32 v203, v93, v89, s60
    v_perm_b32 v207, v93, v89, s61
    v_perm_b32 v211, v94, v90, s60
    v_perm_b32 v215, v94, v90, s61
    v_perm_b32 v219, v95, v91, s60
    v_perm_b32 v223, v95, v91, s61
    s_waitcnt vmcnt(19) lgkmcnt(0)
    v_perm_b32 v64, v100, v96, s60
    v_perm_b32 v68, v100, v96, s61
    v_perm_b32 v72, v101, v97, s60
    v_perm_b32 v76, v101, v97, s61
    v_perm_b32 v80, v102, v98, s60
    v_perm_b32 v84, v102, v98, s61
    v_perm_b32 v88, v103, v99, s60
    v_perm_b32 v92, v103, v99, s61
    v_mfma_f32_16x16x32_bf16 v[32:35], v[224:227], v[192:195], 0
    v_mfma_f32_16x16x32_bf16 v[36:39], v[224:227], v[196:199], 0
    v_perm_b32 v65, v108, v104, s60
    v_perm_b32 v69, v108, v104, s61
    v_perm_b32 v73, v109, v105, s60
    v_perm_b32 v77, v109, v105, s61
    v_perm_b32 v81, v110, v106, s60
    v_perm_b32 v85, v110, v106, s61
    v_perm_b32 v89, v111, v107, s60
    v_perm_b32 v93, v111, v107, s61
    v_mfma_f32_16x16x32_bf16 v[40:43], v[224:227], v[200:203], 0
    v_mfma_f32_16x16x32_bf16 v[44:47], v[224:227], v[204:207], 0
    v_perm_b32 v66, v116, v112, s60
    v_perm_b32 v70, v116, v112, s61
    v_perm_b32 v74, v117, v113, s60
    v_perm_b32 v78, v117, v113, s61
    v_perm_b32 v82, v118, v114, s60
    v_perm_b32 v86, v118, v114, s61
    v_perm_b32 v90, v119, v115, s60
    v_perm_b32 v94, v119, v115, s61
    v_mfma_f32_16x16x32_bf16 v[48:51], v[224:227], v[208:211], 0
    v_mfma_f32_16x16x32_bf16 v[52:55], v[224:227], v[212:215], 0
    v_perm_b32 v67, v124, v120, s60
    v_perm_b32 v71, v124, v120, s61
    v_perm_b32 v75, v125, v121, s60
    v_perm_b32 v79, v125, v121, s61
    v_perm_b32 v83, v126, v122, s60
    v_perm_b32 v87, v126, v122, s61
    v_perm_b32 v91, v127, v123, s60
    v_perm_b32 v95, v127, v123, s61
    v_mfma_f32_16x16x32_bf16 v[56:59], v[224:227], v[216:219], 0
    v_mfma_f32_16x16x32_bf16 v[60:63], v[224:227], v[220:223], 0
    s_waitcnt vmcnt(11)
    v_perm_b32 v96, v132, v128, s60
    v_perm_b32 v100, v132, v128, s61
    v_perm_b32 v104, v133, v129, s60
    v_perm_b32 v108, v133, v129, s61
    v_perm_b32 v112, v134, v130, s60
    v_perm_b32 v116, v134, v130, s61
    v_perm_b32 v120, v135, v131, s60
    v_perm_b32 v124, v135, v131, s61
    v_mfma_f32_16x16x32_bf16 v[32:35], v[228:231], v[64:67], v[32:35]
    v_mfma_f32_16x16x32_bf16 v[36:39], v[228:231], v[68:71], v[36:39]
    v_perm_b32 v97, v140, v136, s60
    v_perm_b32 v101, v140, v136, s61
    v_perm_b32 v105, v141, v137, s60
    v_perm_b32 v109, v141, v137, s61
    v_perm_b32 v113, v142, v138, s60
    v_perm_b32 v117, v142, v138, s61
    v_perm_b32 v121, v143, v139, s60
    v_perm_b32 v125, v143, v139, s61
    v_mfma_f32_16x16x32_bf16 v[40:43], v[228:231], v[72:75], v[40:43]
    v_mfma_f32_16x16x32_bf16 v[44:47], v[228:231], v[76:79], v[44:47]
    v_perm_b32 v98, v148, v144, s60
    v_perm_b32 v102, v148, v144, s61
    v_perm_b32 v106, v149, v145, s60
    v_perm_b32 v110, v149, v145, s61
    v_perm_b32 v114, v150, v146, s60
    v_perm_b32 v118, v150, v146, s61
    v_perm_b32 v122, v151, v147, s60
    v_perm_b32 v126, v151, v147, s61
    v_mfma_f32_16x16x32_bf16 v[48:51], v[228:231], v[80:83], v[48:51]
    v_mfma_f32_16x16x32_bf16 v[52:55], v[228:231], v[84:87], v[52:55]
    v_perm_b32 v99, v156, v152, s60
    v_perm_b32 v103, v156, v152, s61
    v_perm_b32 v107, v157, v153, s60
    v_perm_b32 v111, v157, v153, s61
    v_perm_b32 v115, v158, v154, s60
    v_perm_b32 v119, v158, v154, s61
    v_perm_b32 v123, v159, v155, s60
    v_perm_b32 v127, v159, v155, s61
    v_mfma_f32_16x16x32_bf16 v[56:59], v[228:231], v[88:91], v[56:59]
    v_mfma_f32_16x16x32_bf16 v[60:63], v[228:231], v[92:95], v[60:63]
    v_mfma_f32_16x16x32_bf16 v[32:35], v[232:235], v[96:99], v[32:35]
    v_mfma_f32_16x16x32_bf16 v[36:39], v[232:235], v[100:103], v[36:39]
    v_mfma_f32_16x16x32_bf16 v[40:43], v[232:235], v[104:107], v[40:43]
    v_mfma_f32_16x16x32_bf16 v[44:47], v[232:235], v[108:111], v[44:47]
    s_waitcnt vmcnt(9)
    v_perm_b32 v128, v164, v160, s60
    v_perm_b32 v132, v164, v160, s61
    v_perm_b32 v136, v165, v161, s60
    v_perm_b32 v140, v165, v161, s61
    v_perm_b32 v144, v166, v162, s60
    v_perm_b32 v148, v166, v162, s61
    v_perm_b32 v152, v167, v163, s60
    v_perm_b32 v156, v167, v163, s61
    v_mfma_f32_16x16x32_bf16 v[48:51], v[232:235], v[112:115], v[48:51]
    s_waitcnt vmcnt(7)
    v_perm_b32 v129, v172, v168, s60
    v_perm_b32 v133, v172, v168, s61
    v_perm_b32 v137, v173, v169, s60
    v_perm_b32 v141, v173, v169, s61
    v_perm_b32 v145, v174, v170, s60
    v_perm_b32 v149, v174, v170, s61
    v_perm_b32 v153, v175, v171, s60
    v_perm_b32 v157, v175, v171, s61
    v_mfma_f32_16x16x32_bf16 v[52:55], v[232:235], v[116:119], v[52:55]
    s_waitcnt vmcnt(5)
    v_perm_b32 v130, v180, v176, s60
    v_perm_b32 v134, v180, v176, s61
    v_perm_b32 v138, v181, v177, s60
    v_perm_b32 v142, v181, v177, s61
    v_perm_b32 v146, v182, v178, s60
    v_perm_b32 v150, v182, v178, s61
    v_perm_b32 v154, v183, v179, s60
    v_perm_b32 v158, v183, v179, s61
    v_mfma_f32_16x16x32_bf16 v[56:59], v[232:235], v[120:123], v[56:59]
    s_waitcnt vmcnt(3)
    v_perm_b32 v131, v188, v184, s60
    v_perm_b32 v135, v188, v184, s61
    v_perm_b32 v139, v189, v185, s60
    v_perm_b32 v143, v189, v185, s61
    v_perm_b32 v147, v190, v186, s60
    v_perm_b32 v151, v190, v186, s61
    v_perm_b32 v155, v191, v187, s60
    v_perm_b32 v159, v191, v187, s61
    v_mfma_f32_16x16x32_bf16 v[60:63], v[232:235], v[124:127], v[60:63]
    s_nop 0
    v_mfma_f32_16x16x32_bf16 v[32:35], v[236:239], v[128:131], v[32:35]
    v_mfma_f32_16x16x32_bf16 v[36:39], v[236:239], v[132:135], v[36:39]
    v_mfma_f32_16x16x32_bf16 v[40:43], v[236:239], v[136:139], v[40:43]
    v_mfma_f32_16x16x32_bf16 v[44:47], v[236:239], v[140:143], v[44:47]
    v_mfma_f32_16x16x32_bf16 v[48:51], v[236:239], v[144:147], v[48:51]
    v_mfma_f32_16x16x32_bf16 v[52:55], v[236:239], v[148:151], v[52:55]
    v_mfma_f32_16x16x32_bf16 v[56:59], v[236:239], v[152:155], v[56:59]
    v_mfma_f32_16x16x32_bf16 v[60:63], v[236:239], v[156:159], v[60:63]
    v_mov_b32 v17, s8
    s_nop 6
    ds_write2_b32 v20, v32, v36 offset0:0 offset1:1
    ds_write2_b32 v20, v40, v44 offset0:2 offset1:3
    ds_write2_b32 v20, v48, v52 offset0:4 offset1:5
    ds_write2_b32 v20, v56, v60 offset0:6 offset1:7
    ds_write_b32 v11, v0 offset:96
L_wf_4:
    ds_read_b128 v[24:27], v7 offset:96
    s_waitcnt lgkmcnt(0)
    v_and_b32 v24, v24, v25
    v_and_b32 v26, v26, v27
    v_and_b32 v24, v24, v26
    v_cmp_ne_u32 vcc, 1, v24
    s_cbranch_vccnz L_wf_4
    ds_read_b64 v[24:25], v21 offset:0
    ds_read_b64 v[26:27], v21 offset:2048
    ds_read_b64 v[28:29], v21 offset:4096
    ds_read_b64 v[30:31], v21 offset:6144
    s_waitcnt lgkmcnt(0)
    v_add_f32 v24, v24, v26
    v_add_f32 v28, v28, v30
    v_add_f32 v25, v25, v27
    v_add_f32 v29, v29, v31
    v_add_f32 v24, v24, v28
    v_add_f32 v25, v25, v29
    v_cvt_pk_bf16_f32 v16, v24, v25
    buffer_store_dwordx2 v[16:17], v13, s[56:59], s66 offen sc1
    s_setprio 3
    s_mov_b32 s69, 1069066811
    s_cmp_eq_u32 s97, 0
    s_cbranch_scc1 L_roleA
    s_cmp_eq_u32 s97, 1
    s_cbranch_scc1 L_roleB
    s_cmp_eq_u32 s97, 2
    s_cbranch_scc1 L_roleC
    s_branch L_endrole
L_k2:
    s_mov_b32 s26, 33554432
    s_mov_b32 s27, 0x20000
    s_mov_b32 s34, 4194304
    s_mov_b32 s35, 0x20000
    s_mov_b32 s38, 1835008
    s_mov_b32 s39, 0x20000
    s_mov_b32 s42, 3584
    s_mov_b32 s43, 0x20000
    s_mov_b32 s46, 1835008
    s_mov_b32 s47, 0x20000
    s_mov_b32 s50, 1024
    s_mov_b32 s51, 0x20000
    s_mov_b32 s54, 4096
    s_mov_b32 s55, 0x20000
    s_lshl_b32 s87, s4, 3
    s_mov_b32 s98, 336860180
    s_mov_b32 s99, 168561678
    s_lshr_b64 s[98:99], s[98:99], s87
    s_and_b32 s10, s98, 0xff
    s_mov_b32 s98, 117901063
    s_mov_b32 s99, 117901063
    s_lshr_b64 s[98:99], s[98:99], s87
    s_and_b32 s12, s98, 0xff
    s_mov_b32 s98, 84215045
    s_mov_b32 s99, 185273099
    s_lshr_b64 s[98:99], s[98:99], s87
    s_and_b32 s13, s98, 0xff
    s_mov_b32 s98, 1009259520
    s_mov_b32 s99, 1986682448
    s_lshr_b64 s[98:99], s[98:99], s87
    s_and_b32 s14, s98, 0xff
    s_add_u32 s15, s14, s7
    s_mov_b32 s98, 353240832
    s_mov_b32 s99, 824845084
    s_lshr_b64 s[98:99], s[98:99], s87
    s_and_b32 s14, s98, 0xff
    s_sub_u32 s10, s7, s10
    s_add_u32 s9, s14, s10
    s_mov_b32 s97, 3
    s_sub_u32 s76, s10, s12
    s_cmp_lt_u32 s76, s13
    s_cselect_b32 s97, 2, s97
    s_cmp_lt_u32 s10, s12
    s_cselect_b32 s97, 1, s97
    s_cmp_gt_u32 s10, s7
    s_cselect_b32 s97, 0, s97
    s_mov_b32 s98, 252314880
    s_mov_b32 s99, 891952916
    s_lshr_b64 s[98:99], s[98:99], s87
    s_and_b32 s14, s98, 0xff
    s_add_u32 s13, s14, s76
    s_lshr_b32 s84, s15, 4
    s_and_b32 s84, s84, 7
    s_lshr_b32 s85, s15, 2
    s_and_b32 s85, s85, 3
    s_and_b32 s86, s15, 3
    s_lshr_b32 s76, s13, 4
    s_and_b32 s76, s76, 3
    s_and_b32 s10, s13, 15
    s_lshl_b32 s62, s10, 5
    s_mov_b32 s63, 0xffff0000
    v_mov_b32 v7, 117760
    s_lshl_b32 s10, s11, 2
    v_add_u32 v11, s10, v7
    v_lshlrev_b32 v13, 3, v1
    s_waitcnt vmcnt(8)
    v_readfirstlane_b32 s8, v5
    s_mov_b32 s67, 0
    s_add_u32 s8, s8, 2654435769
    v_mov_b32 v15, s8
    s_branch L_qg2_6
L_qg_5:
    buffer_load_dwordx4 v[16:19], v14, s[56:59], s66 offen sc1
    buffer_load_dwordx4 v[20:23], v14, s[56:59], s72 offen sc1
    buffer_load_dwordx4 v[24:27], v14, s[56:59], s73 offen sc1
    buffer_load_dwordx4 v[28:31], v14, s[56:59], s74 offen sc1
    s_waitcnt vmcnt(0)
L_qg2_6:
    v_xor_b32 v44, s8, v17
    v_xor_b32 v40, s8, v19
    v_or_b32 v40, v40, v44
    v_xor_b32 v44, s8, v21
    v_xor_b32 v45, s8, v23
    v_or3_b32 v40, v40, v44, v45
    v_xor_b32 v44, s8, v25
    v_xor_b32 v45, s8, v27
    v_or3_b32 v40, v40, v44, v45
    v_xor_b32 v44, s8, v29
    v_xor_b32 v45, s8, v31
    v_or3_b32 v40, v40, v44, v45
    v_cmp_ne_u32 vcc, 0, v40
    s_cbranch_vccz L_pd_7
    s_mov_b64 exec, vcc
    s_sleep 2
    s_add_u32 s67, s67, 1
    s_cmp_lt_u32 s67, 20000
    s_cbranch_scc1 L_qg_5
L_pd_7:
    s_mov_b64 exec, -1
    v_add_f32 v16, v16, v20
    v_add_f32 v24, v24, v28
    v_add_f32 v18, v18, v22
    v_add_f32 v26, v26, v30
    v_add_f32 v16, v16, v24
    v_add_f32 v18, v18, v26
    v_cvt_pk_bf16_f32 v40, v16, v18
    s_lshl_b32 s10, s11, 8
    s_add_u32 s10, s10, 116736
    v_lshlrev_b32 v10, 2, v1
    v_add_u32 v10, s10, v10
    ds_write_b32 v10, v40
    ds_write_b32 v11, v0 offset:32
    v_and_b32 v10, 3, v2
    v_lshlrev_b32 v10, 8, v10
    v_lshlrev_b32 v44, 4, v3
    v_add_u32 v10, v10, v44
    v_add_u32 v10, 116736, v10
L_wf_8:
    ds_read_b128 v[40:43], v7 offset:32
    s_waitcnt lgkmcnt(0)
    v_and_b32 v40, v40, v41
    v_and_b32 v42, v42, v43
    v_and_b32 v40, v40, v42
    v_cmp_ne_u32 vcc, 1, v40
    s_cbranch_vccnz L_wf_8
    ds_read_b128 v[16:19], v10 offset:0
    ds_read_b128 v[20:23], v10 offset:64
    ds_read_b128 v[24:27], v10 offset:128
    ds_read_b128 v[28:31], v10 offset:192
    s_waitcnt lgkmcnt(0)
    v_mfma_f32_16x16x32_bf16 v[32:35], v[16:19], v[64:67], 0
    v_mfma_f32_16x16x32_bf16 v[32:35], v[20:23], v[68:71], v[32:35]
    v_mfma_f32_16x16x32_bf16 v[32:35], v[24:27], v[72:75], v[32:35]
    v_mfma_f32_16x16x32_bf16 v[32:35], v[28:31], v[76:79], v[32:35]
    v_mfma_f32_16x16x32_bf16 v[36:39], v[16:19], v[80:83], 0
    v_mfma_f32_16x16x32_bf16 v[36:39], v[20:23], v[84:87], v[36:39]
    v_mfma_f32_16x16x32_bf16 v[36:39], v[24:27], v[88:91], v[36:39]
    v_mfma_f32_16x16x32_bf16 v[36:39], v[28:31], v[92:95], v[36:39]
    v_mfma_f32_16x16x32_bf16 v[40:43], v[16:19], v[96:99], 0
    v_mfma_f32_16x16x32_bf16 v[40:43], v[20:23], v[100:103], v[40:43]
    v_mfma_f32_16x16x32_bf16 v[40:43], v[24:27], v[104:107], v[40:43]
    v_mfma_f32_16x16x32_bf16 v[40:43], v[28:31], v[108:111], v[40:43]
    v_mfma_f32_16x16x32_bf16 v[44:47], v[16:19], v[112:115], 0
    v_mfma_f32_16x16x32_bf16 v[44:47], v[20:23], v[116:119], v[44:47]
    v_mfma_f32_16x16x32_bf16 v[44:47], v[24:27], v[120:123], v[44:47]
    v_mfma_f32_16x16x32_bf16 v[44:47], v[28:31], v[124:127], v[44:47]
    v_mfma_f32_16x16x32_bf16 v[48:51], v[16:19], v[128:131], 0
    v_mfma_f32_16x16x32_bf16 v[48:51], v[20:23], v[132:135], v[48:51]
    v_mfma_f32_16x16x32_bf16 v[48:51], v[24:27], v[136:139], v[48:51]
    v_mfma_f32_16x16x32_bf16 v[48:51], v[28:31], v[140:143], v[48:51]
    v_mfma_f32_16x16x32_bf16 v[52:55], v[16:19], v[144:147], 0
    v_mfma_f32_16x16x32_bf16 v[52:55], v[20:23], v[148:151], v[52:55]
    v_mfma_f32_16x16x32_bf16 v[52:55], v[24:27], v[152:155], v[52:55]
    v_mfma_f32_16x16x32_bf16 v[52:55], v[28:31], v[156:159], v[52:55]
    s_waitcnt vmcnt(4)
    v_mfma_f32_16x16x32_bf16 v[56:59], v[16:19], v[160:163], 0
    v_mfma_f32_16x16x32_bf16 v[56:59], v[20:23], v[164:167], v[56:59]
    v_mfma_f32_16x16x32_bf16 v[56:59], v[24:27], v[168:171], v[56:59]
    v_mfma_f32_16x16x32_bf16 v[56:59], v[28:31], v[172:175], v[56:59]
    s_waitcnt vmcnt(0)
    v_mfma_f32_16x16x32_bf16 v[60:63], v[16:19], v[176:179], 0
    v_mfma_f32_16x16x32_bf16 v[60:63], v[20:23], v[180:183], v[60:63]
    v_mfma_f32_16x16x32_bf16 v[60:63], v[24:27], v[184:187], v[60:63]
    v_mfma_f32_16x16x32_bf16 v[60:63], v[28:31], v[188:191], v[60:63]
    s_mov_b32 s68, 1035273459
    s_mov_b32 s69, 1069066811
    s_nop 5
    v_mov_b32_dpp v32, v36 quad_perm:[0,1,2,3] row_mask:0x2 bank_mask:0xf
    v_mov_b32_dpp v33, v37 quad_perm:[0,1,2,3] row_mask:0x2 bank_mask:0xf
    v_mov_b32_dpp v34, v38 quad_perm:[0,1,2,3] row_mask:0x2 bank_mask:0xf
    v_mov_b32_dpp v35, v39 quad_perm:[0,1,2,3] row_mask:0x2 bank_mask:0xf
    v_mov_b32_dpp v32, v40 quad_perm:[0,1,2,3] row_mask:0x4 bank_mask:0xf
    v_mov_b32_dpp v33, v41 quad_perm:[0,1,2,3] row_mask:0x4 bank_mask:0xf
    v_mov_b32_dpp v34, v42 quad_perm:[0,1,2,3] row_mask:0x4 bank_mask:0xf
    v_mov_b32_dpp v35, v43 quad_perm:[0,1,2,3] row_mask:0x4 bank_mask:0xf
    v_mov_b32_dpp v32, v44 quad_perm:[0,1,2,3] row_mask:0x8 bank_mask:0xf
    v_mov_b32_dpp v33, v45 quad_perm:[0,1,2,3] row_mask:0x8 bank_mask:0xf
    v_mov_b32_dpp v34, v46 quad_perm:[0,1,2,3] row_mask:0x8 bank_mask:0xf
    v_mov_b32_dpp v35, v47 quad_perm:[0,1,2,3] row_mask:0x8 bank_mask:0xf
    v_mov_b32_dpp v48, v52 quad_perm:[0,1,2,3] row_mask:0x2 bank_mask:0xf
    v_mov_b32_dpp v49, v53 quad_perm:[0,1,2,3] row_mask:0x2 bank_mask:0xf
    v_mov_b32_dpp v50, v54 quad_perm:[0,1,2,3] row_mask:0x2 bank_mask:0xf
    v_mov_b32_dpp v51, v55 quad_perm:[0,1,2,3] row_mask:0x2 bank_mask:0xf
    v_mov_b32_dpp v48, v56 quad_perm:[0,1,2,3] row_mask:0x4 bank_mask:0xf
    v_mov_b32_dpp v49, v57 quad_perm:[0,1,2,3] row_mask:0x4 bank_mask:0xf
    v_mov_b32_dpp v50, v58 quad_perm:[0,1,2,3] row_mask:0x4 bank_mask:0xf
    v_mov_b32_dpp v51, v59 quad_perm:[0,1,2,3] row_mask:0x4 bank_mask:0xf
    v_mov_b32_dpp v48, v60 quad_perm:[0,1,2,3] row_mask:0x8 bank_mask:0xf
    v_mov_b32_dpp v49, v61 quad_perm:[0,1,2,3] row_mask:0x8 bank_mask:0xf
    v_mov_b32_dpp v50, v62 quad_perm:[0,1,2,3] row_mask:0x8 bank_mask:0xf
    v_mov_b32_dpp v51, v63 quad_perm:[0,1,2,3] row_mask:0x8 bank_mask:0xf
    v_cvt_pk_bf16_f32 v36, v32, v33
    v_cvt_pk_bf16_f32 v37, v34, v35
    v_cvt_pk_bf16_f32 v38, v48, v49
    v_cvt_pk_bf16_f32 v39, v50, v51
    v_lshlrev_b32 v32, 16, v36
    v_and_b32 v33, s63, v36
    v_lshlrev_b32 v34, 16, v37
    v_and_b32 v35, s63, v37
    v_lshlrev_b32 v48, 16, v38
    v_and_b32 v49, s63, v38
    v_lshlrev_b32 v50, 16, v39
    v_and_b32 v51, s63, v39
    v_mul_f32 v32, s68, v32
    v_mul_f32 v33, s68, v33
    v_mul_f32 v34, s68, v34
    v_mul_f32 v35, s68, v35
    v_mul_f32 v48, s68, v48
    v_mul_f32 v49, s68, v49
    v_mul_f32 v50, s68, v50
    v_mul_f32 v51, s68, v51
    v_cvt_pk_bf16_f32 v36, v32, v33
    v_cvt_pk_bf16_f32 v37, v34, v35
    v_cvt_pk_bf16_f32 v38, v48, v49
    v_cvt_pk_bf16_f32 v39, v50, v51
    v_lshlrev_b32 v32, 16, v36
    v_and_b32 v33, s63, v36
    v_lshlrev_b32 v34, 16, v37
    v_and_b32 v35, s63, v37
    v_lshlrev_b32 v48, 16, v38
    v_and_b32 v49, s63, v38
    v_lshlrev_b32 v50, 16, v39
    v_and_b32 v51, s63, v39
    v_max_f32 v40, v32, v48
    v_max_f32 v41, v33, v49
    v_max_f32 v42, v34, v50
    v_max_f32 v43, v35, v51
    v_max_f32_dpp v40, v40, v40 row_ror:8 row_mask:0xf bank_mask:0xf
    v_max_f32_dpp v41, v41, v41 row_ror:8 row_mask:0xf bank_mask:0xf
    v_max_f32_dpp v42, v42, v42 row_ror:8 row_mask:0xf bank_mask:0xf
    v_max_f32_dpp v43, v43, v43 row_ror:8 row_mask:0xf bank_mask:0xf
    v_max_f32_dpp v40, v40, v40 row_ror:4 row_mask:0xf bank_mask:0xf
    v_max_f32_dpp v41, v41, v41 row_ror:4 row_mask:0xf bank_mask:0xf
    v_max_f32_dpp v42, v42, v42 row_ror:4 row_mask:0xf bank_mask:0xf
    v_max_f32_dpp v43, v43, v43 row_ror:4 row_mask:0xf bank_mask:0xf
    v_max_f32_dpp v40, v40, v40 row_ror:2 row_mask:0xf bank_mask:0xf
    v_max_f32_dpp v41, v41, v41 row_ror:2 row_mask:0xf bank_mask:0xf
    v_max_f32_dpp v42, v42, v42 row_ror:2 row_mask:0xf bank_mask:0xf
    v_max_f32_dpp v43, v43, v43 row_ror:2 row_mask:0xf bank_mask:0xf
    v_max_f32_dpp v40, v40, v40 row_ror:1 row_mask:0xf bank_mask:0xf
    v_max_f32_dpp v41, v41, v41 row_ror:1 row_mask:0xf bank_mask:0xf
    v_max_f32_dpp v42, v42, v42 row_ror:1 row_mask:0xf bank_mask:0xf
    v_max_f32_dpp v43, v43, v43 row_ror:1 row_mask:0xf bank_mask:0xf
    v_mov_b32 v44, v40
    v_mov_b32 v45, v41
    v_mov_b32 v46, v42
    v_mov_b32 v47, v43
    s_nop 0
    v_permlane16_swap_b32 v40, v44
    v_permlane16_swap_b32 v41, v45
    v_permlane16_swap_b32 v42, v46
    v_permlane16_swap_b32 v43, v47
    v_max_f32 v40, v40, v44
    v_max_f32 v41, v41, v45
    v_max_f32 v42, v42, v46
    v_max_f32 v43, v43, v47
    v_mov_b32 v44, v40
    v_mov_b32 v45, v41
    v_mov_b32 v46, v42
    v_mov_b32 v47, v43
    s_nop 0
    v_permlane32_swap_b32 v40, v44
    v_permlane32_swap_b32 v41, v45
    v_permlane32_swap_b32 v42, v46
    v_permlane32_swap_b32 v43, v47
    v_max_f32 v40, v40, v44
    v_max_f32 v41, v41, v45
    v_max_f32 v42, v42, v46
    v_max_f32 v43, v43, v47
    v_sub_f32 v32, v32, v40
    v_sub_f32 v33, v33, v41
    v_sub_f32 v34, v34, v42
    v_sub_f32 v35, v35, v43
    v_sub_f32 v48, v48, v40
    v_sub_f32 v49, v49, v41
    v_sub_f32 v50, v50, v42
    v_sub_f32 v51, v51, v43
    v_mul_f32 v32, s69, v32
    v_mul_f32 v33, s69, v33
    v_mul_f32 v34, s69, v34
    v_mul_f32 v35, s69, v35
    v_mul_f32 v48, s69, v48
    v_mul_f32 v49, s69, v49
    v_mul_f32 v50, s69, v50
    v_mul_f32 v51, s69, v51
    v_exp_f32 v32, v32
    v_exp_f32 v33, v33
    v_exp_f32 v34, v34
    v_exp_f32 v35, v35
    v_exp_f32 v48, v48
    v_exp_f32 v49, v49
    v_exp_f32 v50, v50
    v_exp_f32 v51, v51
    s_nop 0
    v_add_f32 v52, v32, v48
    v_add_f32 v53, v33, v49
    v_add_f32 v54, v34, v50
    v_add_f32 v55, v35, v51
    v_add_f32_dpp v52, v52, v52 row_ror:8 row_mask:0xf bank_mask:0xf
    v_add_f32_dpp v53, v53, v53 row_ror:8 row_mask:0xf bank_mask:0xf
    v_add_f32_dpp v54, v54, v54 row_ror:8 row_mask:0xf bank_mask:0xf
    v_add_f32_dpp v55, v55, v55 row_ror:8 row_mask:0xf bank_mask:0xf
    v_add_f32_dpp v52, v52, v52 row_ror:4 row_mask:0xf bank_mask:0xf
    v_add_f32_dpp v53, v53, v53 row_ror:4 row_mask:0xf bank_mask:0xf
    v_add_f32_dpp v54, v54, v54 row_ror:4 row_mask:0xf bank_mask:0xf
    v_add_f32_dpp v55, v55, v55 row_ror:4 row_mask:0xf bank_mask:0xf
    v_add_f32_dpp v52, v52, v52 row_ror:2 row_mask:0xf bank_mask:0xf
    v_add_f32_dpp v53, v53, v53 row_ror:2 row_mask:0xf bank_mask:0xf
    v_add_f32_dpp v54, v54, v54 row_ror:2 row_mask:0xf bank_mask:0xf
    v_add_f32_dpp v55, v55, v55 row_ror:2 row_mask:0xf bank_mask:0xf
    v_add_f32_dpp v52, v52, v52 row_ror:1 row_mask:0xf bank_mask:0xf
    v_add_f32_dpp v53, v53, v53 row_ror:1 row_mask:0xf bank_mask:0xf
    v_add_f32_dpp v54, v54, v54 row_ror:1 row_mask:0xf bank_mask:0xf
    v_add_f32_dpp v55, v55, v55 row_ror:1 row_mask:0xf bank_mask:0xf
    v_mov_b32 v44, v52
    v_mov_b32 v45, v53
    v_mov_b32 v46, v54
    v_mov_b32 v47, v55
    s_nop 0
    v_permlane16_swap_b32 v52, v44
    v_permlane16_swap_b32 v53, v45
    v_permlane16_swap_b32 v54, v46
    v_permlane16_swap_b32 v55, v47
    v_add_f32 v52, v52, v44
    v_add_f32 v53, v53, v45
    v_add_f32 v54, v54, v46
    v_add_f32 v55, v55, v47
    v_mov_b32 v44, v52
    v_mov_b32 v45, v53
    v_mov_b32 v46, v54
    v_mov_b32 v47, v55
    s_nop 0
    v_permlane32_swap_b32 v52, v44
    v_permlane32_swap_b32 v53, v45
    v_permlane32_swap_b32 v54, v46
    v_permlane32_swap_b32 v55, v47
    v_add_f32 v52, v52, v44
    v_add_f32 v53, v53, v45
    v_add_f32 v54, v54, v46
    v_add_f32 v55, v55, v47
    v_mov_b32 v56, v40
    v_mov_b32 v57, v52
    v_mov_b32 v58, v41
    v_mov_b32 v59, v53
    v_mov_b32 v60, v42
    v_mov_b32 v61, v54
    v_mov_b32 v62, v43
    v_mov_b32 v63, v55
    s_lshl_b32 s10, s11, 5
    s_add_u32 s10, s10, 118016
    v_mov_b32 v10, s10
    ds_write_b128 v10, v[56:59]
    ds_write_b128 v10, v[60:63] offset:16
    ds_write_b32 v11, v0 offset:48
    v_lshlrev_b32 v10, 3, v2
    v_add_u32 v10, 118016, v10
    v_lshrrev_b32 v9, 5, v1
    v_lshlrev_b32 v9, 8, v9
    v_and_b32 v44, 3, v1
    v_lshlrev_b32 v44, 4, v44
    v_add_u32 v9, v9, v44
    v_and_b32 v44, 31, v1
    v_lshrrev_b32 v44, 2, v44
    v_lshlrev_b32 v44, 1, v44
    v_add_u32 v9, v9, v44
    s_lshl_b32 s10, s11, 10
    s_add_u32 s10, s10, 106496
    v_add_u32 v9, s10, v9
L_wf_9:
    ds_read_b128 v[44:47], v7 offset:48
    s_waitcnt lgkmcnt(0)
    v_and_b32 v44, v44, v45
    v_and_b32 v46, v46, v47
    v_and_b32 v44, v44, v46
    v_cmp_ne_u32 vcc, 1, v44
    s_cbranch_vccnz L_wf_9
    ds_read_b64 v[192:193], v10
    s_waitcnt lgkmcnt(0)
    v_mov_b32 v194, v192
    s_nop 1
    v_max_f32_dpp v194, v194, v194 row_ror:4 row_mask:0xf bank_mask:0xf
    s_nop 1
    v_max_f32_dpp v194, v194, v194 row_ror:8 row_mask:0xf bank_mask:0xf
    v_sub_f32 v195, v192, v194
    v_mul_f32 v195, s69, v195
    v_exp_f32 v195, v195
    s_nop 0
    v_mul_f32 v196, v193, v195
    s_nop 1
    v_add_f32_dpp v196, v196, v196 row_ror:4 row_mask:0xf bank_mask:0xf
    s_nop 1
    v_add_f32_dpp v196, v196, v196 row_ror:8 row_mask:0xf bank_mask:0xf
    v_rcp_f32 v197, v196
    s_nop 0
    v_mul_f32 v197, v197, v195
    s_lshl_b32 s10, s11, 2
    s_add_u32 s12, s10, 0
    v_readlane_b32 s72, v197, s12
    s_add_u32 s12, s10, 1
    v_readlane_b32 s73, v197, s12
    s_add_u32 s12, s10, 2
    v_readlane_b32 s74, v197, s12
    s_add_u32 s12, s10, 3
    v_readlane_b32 s75, v197, s12
    v_mov_b32 v56, v194
    v_mov_b32 v57, s8
    v_mov_b32 v58, v196
    v_mov_b32 v59, s8
    v_mul_f32 v32, s72, v32
    v_mul_f32 v33, s73, v33
    v_mul_f32 v34, s74, v34
    v_mul_f32 v35, s75, v35
    v_mul_f32 v48, s72, v48
    v_mul_f32 v49, s73, v49
    v_mul_f32 v50, s74, v50
    v_mul_f32 v51, s75, v51
    v_cvt_pk_bf16_f32 v36, v32, v33
    v_cvt_pk_bf16_f32 v37, v34, v35
    v_cvt_pk_bf16_f32 v38, v48, v49
    v_cvt_pk_bf16_f32 v39, v50, v51
    ds_write_b16 v9, v36 offset:0
    ds_write_b16_d16_hi v9, v36 offset:64
    ds_write_b16 v9, v37 offset:128
    ds_write_b16_d16_hi v9, v37 offset:192
    ds_write_b16 v9, v38 offset:512
    ds_write_b16_d16_hi v9, v38 offset:576
    ds_write_b16 v9, v39 offset:640
    ds_write_b16_d16_hi v9, v39 offset:704
    ds_write_b32 v11, v0 offset:64
    s_lshl_b32 s10, s70, 3
    s_add_u32 s10, s10, s6
    s_lshl_b32 s10, s10, 6
    s_lshl_b32 s12, s11, 4
    s_add_u32 s10, s10, s12
    s_add_u32 s10, s10, 4096
    s_lshl_b64 s[12:13], 1, s11
    s_mov_b64 exec, s[12:13]
    buffer_store_dwordx4 v[56:59], v6, s[56:59], s10 offen sc1
    s_mov_b64 exec, -1
    s_cmp_eq_u32 s97, 0
    s_cbranch_scc1 L_kA
    s_cmp_eq_u32 s97, 1
    s_cbranch_scc1 L_kB
    s_branch L_fin
L_kA:
    s_mov_b32 s72, s85
    v_lshrrev_b32 v22, 1, v2
    v_xor_b32 v22, v22, v3
    v_lshlrev_b32 v22, 5, v22
    v_lshlrev_b32 v23, 10, v3
    v_add_u32 v22, v22, v23
    v_and_b32 v23, 1, v1
    v_lshlrev_b32 v23, 4, v23
    v_add_u32 v22, v22, v23
    v_xor_b32 v23, 0x80, v22
    s_lshl_b32 s14, s84, 2
    s_add_u32 s14, s14, s72
    s_lshl_b32 s14, s14, 17
    s_lshl_b32 s13, s11, 15
    s_add_u32 s14, s14, s13
    s_lshl_b32 s13, s86, 8
    s_add_u32 s14, s14, s13
    s_lshl_b32 s15, s11, 13
    s_cmp_lg_u32 s3, 0
    s_cbranch_scc1 L_kA_dma
    v_lshrrev_b32 v10, 3, v1
    v_and_b32 v10, 3, v10
    v_lshlrev_b32 v10, 12, v10
    v_and_b32 v9, 7, v1
    v_lshlrev_b32 v9, 6, v9
    v_add_u32 v10, v10, v9
    s_lshl_b32 s12, s84, 9
    s_lshl_b32 s10, s72, 4
    s_add_u32 s10, s10, s12
    s_add_u32 s66, s10, 4096
    s_mov_b32 s67, 0
L_mg_10:
    s_sleep 8
    buffer_load_dwordx4 v[192:195], v10, s[56:59], s66 offen sc1
    s_waitcnt vmcnt(0)
    v_xor_b32 v44, s8, v193
    v_xor_b32 v40, s8, v195
    v_or_b32 v40, v40, v44
    v_cmp_ne_u32 vcc, 0, v40
    s_cbranch_vccz L_pd_11
    s_mov_b64 exec, vcc
    s_add_u32 s67, s67, 1
    s_cmp_lt_u32 s67, 20000
    s_cbranch_scc1 L_mg_10
L_pd_11:
    s_mov_b64 exec, -1
    v_mov_b32 v40, v192
    s_nop 1
    v_max_f32_dpp v40, v40, v40 quad_perm:[1,0,3,2] row_mask:0xf bank_mask:0xf
    s_nop 1
    v_max_f32_dpp v40, v40, v40 quad_perm:[2,3,0,1] row_mask:0xf bank_mask:0xf
    s_nop 1
    v_max_f32_dpp v40, v40, v40 row_half_mirror row_mask:0xf bank_mask:0xf
    v_sub_f32 v41, v192, v40
    v_mul_f32 v41, s69, v41
    v_exp_f32 v41, v41
    s_nop 0
    v_mul_f32 v41, v41, v194
    v_mov_b32 v42, v41
    s_nop 1
    v_add_f32_dpp v42, v42, v42 quad_perm:[1,0,3,2] row_mask:0xf bank_mask:0xf
    s_nop 1
    v_add_f32_dpp v42, v42, v42 quad_perm:[2,3,0,1] row_mask:0xf bank_mask:0xf
    s_nop 1
    v_add_f32_dpp v42, v42, v42 row_half_mirror row_mask:0xf bank_mask:0xf
    v_rcp_f32 v42, v42
    s_nop 0
    v_mul_f32 v41, v41, v42
    v_and_b32 v9, 31, v1
    v_lshlrev_b32 v9, 2, v9
    v_add_u32 v9, 118784, v9
    ds_write_b32 v9, v41
    ds_write_b32 v11, v0 offset:112
L_kA_dma:
    s_setprio 0
L_wf_12:
    s_sleep 2
    ds_read_b128 v[44:47], v7 offset:144
    s_waitcnt lgkmcnt(0)
    v_and_b32 v44, v44, v45
    v_and_b32 v46, v46, v47
    v_and_b32 v44, v44, v46
    v_cmp_ne_u32 vcc, 1, v44
    s_cbranch_vccnz L_wf_12
    s_mov_b32 m0, s15
    s_add_u32 s15, s15, 1024
    buffer_load_dwordx4 v22, s[32:35], s14 offen nt lds
    s_add_u32 s14, s14, 4096
    s_mov_b32 m0, s15
    s_add_u32 s15, s15, 1024
    buffer_load_dwordx4 v22, s[32:35], s14 offen nt lds
    s_add_u32 s14, s14, 4096
    s_mov_b32 m0, s15
    s_add_u32 s15, s15, 1024
    buffer_load_dwordx4 v23, s[32:35], s14 offen nt lds
    s_add_u32 s14, s14, 4096
    s_mov_b32 m0, s15
    s_add_u32 s15, s15, 1024
    buffer_load_dwordx4 v23, s[32:35], s14 offen nt lds
    s_add_u32 s14, s14, 4096
    s_mov_b32 m0, s15
    s_add_u32 s15, s15, 1024
    buffer_load_dwordx4 v22, s[32:35], s14 offen nt lds
    s_add_u32 s14, s14, 4096
    s_mov_b32 m0, s15
    s_add_u32 s15, s15, 1024
    buffer_load_dwordx4 v22, s[32:35], s14 offen nt lds
    s_add_u32 s14, s14, 4096
    s_mov_b32 m0, s15
    s_add_u32 s15, s15, 1024
    buffer_load_dwordx4 v23, s[32:35], s14 offen nt lds
    s_add_u32 s14, s14, 4096
    s_mov_b32 m0, s15
    s_add_u32 s15, s15, 1024
    buffer_load_dwordx4 v23, s[32:35], s14 offen nt lds
    s_add_u32 s14, s14, 4096
    s_branch L_roleA
L_kB:
    s_setprio 0
    v_lshrrev_b32 v22, 2, v1
    v_mul_u32_u24 v22, 3584, v22
    v_lshrrev_b32 v23, 1, v1
    v_and_b32 v23, 1, v23
    v_lshrrev_b32 v24, 5, v1
    v_xor_b32 v23, v23, v24
    v_lshlrev_b32 v23, 5, v23
    v_add_u32 v22, v22, v23
    v_and_b32 v23, 1, v1
    v_lshlrev_b32 v23, 4, v23
    v_add_u32 v22, v22, v23
    s_mul_i32 s12, s11, 458752
    s_lshl_b32 s13, s9, 6
    s_add_u32 s12, s12, s13
    s_lshl_b32 s13, s11, 13
    s_and_b32 s10, s11, 1
    s_lshl_b32 s10, s10, 7
    v_xor_b32 v24, s10, v14
    v_xor_b32 v25, 32, v24
    v_xor_b32 v26, 64, v24
    v_xor_b32 v27, 0x60, v24
    s_lshl_b32 s14, s9, 15
    s_lshl_b32 s15, s11, 13
    s_add_u32 s14, s14, s15
    s_add_u32 s15, s15, 32768
L_wf_13:
    s_sleep 2
    ds_read_b128 v[44:47], v7 offset:96
    s_waitcnt lgkmcnt(0)
    v_and_b32 v44, v44, v45
    v_and_b32 v46, v46, v47
    v_and_b32 v44, v44, v46
    v_cmp_ne_u32 vcc, 1, v44
    s_cbranch_vccnz L_wf_13
    s_mov_b32 m0, s13
    s_add_u32 s13, s13, 1024
    buffer_load_dwordx4 v22, s[36:39], s12 offen nt lds
    s_add_u32 s12, s12, 57344
    s_mov_b32 m0, s13
    s_add_u32 s13, s13, 1024
    buffer_load_dwordx4 v22, s[36:39], s12 offen nt lds
    s_add_u32 s12, s12, 57344
    s_mov_b32 m0, s13
    s_add_u32 s13, s13, 1024
    buffer_load_dwordx4 v22, s[36:39], s12 offen nt lds
    s_add_u32 s12, s12, 57344
    s_mov_b32 m0, s13
    s_add_u32 s13, s13, 1024
    buffer_load_dwordx4 v22, s[36:39], s12 offen nt lds
    s_add_u32 s12, s12, 57344
    s_mov_b32 m0, s13
    s_add_u32 s13, s13, 1024
    buffer_load_dwordx4 v22, s[36:39], s12 offen nt lds
    s_add_u32 s12, s12, 57344
    s_mov_b32 m0, s13
    s_add_u32 s13, s13, 1024
    buffer_load_dwordx4 v22, s[36:39], s12 offen nt lds
    s_add_u32 s12, s12, 57344
    s_mov_b32 m0, s13
    s_add_u32 s13, s13, 1024
    buffer_load_dwordx4 v22, s[36:39], s12 offen nt lds
    s_add_u32 s12, s12, 57344
    s_mov_b32 m0, s13
    s_add_u32 s13, s13, 1024
    buffer_load_dwordx4 v22, s[36:39], s12 offen nt lds
    s_add_u32 s12, s12, 57344
    s_mov_b32 m0, s15
    s_add_u32 s15, s15, 1024
    buffer_load_dwordx4 v24, s[44:47], s14 offen nt lds
    s_add_u32 s14, s14, 1024
    s_mov_b32 m0, s15
    s_add_u32 s15, s15, 1024
    buffer_load_dwordx4 v25, s[44:47], s14 offen nt lds
    s_add_u32 s14, s14, 1024
    s_mov_b32 m0, s15
    s_add_u32 s15, s15, 1024
    buffer_load_dwordx4 v26, s[44:47], s14 offen nt lds
    s_add_u32 s14, s14, 1024
    s_mov_b32 m0, s15
    s_add_u32 s15, s15, 1024
    buffer_load_dwordx4 v27, s[44:47], s14 offen nt lds
    s_add_u32 s14, s14, 1024
    s_mov_b32 m0, s15
    s_add_u32 s15, s15, 1024
    buffer_load_dwordx4 v24, s[44:47], s14 offen nt lds
    s_add_u32 s14, s14, 1024
    s_mov_b32 m0, s15
    s_add_u32 s15, s15, 1024
    buffer_load_dwordx4 v25, s[44:47], s14 offen nt lds
    s_add_u32 s14, s14, 1024
    s_mov_b32 m0, s15
    s_add_u32 s15, s15, 1024
    buffer_load_dwordx4 v26, s[44:47], s14 offen nt lds
    s_add_u32 s14, s14, 1024
    s_mov_b32 m0, s15
    s_add_u32 s15, s15, 1024
    buffer_load_dwordx4 v27, s[44:47], s14 offen nt lds
    s_add_u32 s14, s14, 1024
    s_waitcnt vmcnt(0)
    ds_write_b32 v11, v0 offset:80
    s_branch L_roleB
L_roleA:
    s_lshr_b32 s71, s3, 2
    s_mov_b32 s72, s85
    s_mov_b32 s73, s86
    v_lshrrev_b32 v21, 3, v2
    v_lshlrev_b32 v21, 17, v21
    v_and_b32 v9, 7, v2
    v_lshlrev_b32 v9, 11, v9
    v_add_u32 v21, v21, v9
    v_lshlrev_b32 v9, 5, v3
    v_add_u32 v21, v21, v9
    s_lshl_b32 s10, s71, 18
    s_lshl_b32 s12, s84, 14
    s_add_u32 s10, s10, s12
    s_lshl_b32 s12, s72, 9
    s_add_u32 s10, s10, s12
    s_lshl_b32 s12, s11, 7
    s_add_u32 s10, s10, s12
    s_add_u32 s75, s10, 32768
    s_cmp_lt_u32 s3, 4
    s_cbranch_scc1 L_A_common
    buffer_load_dwordx4 v[192:195], v21, s[56:59], s75 offen sc1
    buffer_load_dwordx4 v[196:199], v21, s[56:59], s75 offen offset:16 sc1
L_A_common:
    v_lshrrev_b32 v9, 2, v2
    v_lshlrev_b32 v10, 3, v3
    v_add_u32 v10, v10, v9
    v_lshlrev_b32 v10, 8, v10
    v_and_b32 v44, 3, v2
    v_lshlrev_b32 v44, 3, v44
    v_add_u32 v10, v10, v44
    v_and_b32 v44, 1, v3
    v_lshlrev_b32 v44, 2, v44
    v_or_b32 v44, v44, v9
    v_lshlrev_b32 v44, 5, v44
    v_add_u32 v10, v10, v44
    s_lshl_b32 s10, s11, 13
    v_add_u32 v24, s10, v10
    v_xor_b32 v25, 32, v24
    v_xor_b32 v26, 64, v24
    v_xor_b32 v27, 96, v24
    v_xor_b32 v28, 128, v24
    v_xor_b32 v29, 160, v24
    v_xor_b32 v30, 192, v24
    v_xor_b32 v31, 224, v24
    v_lshrrev_b32 v9, 1, v3
    v_lshlrev_b32 v9, 9, v9
    v_and_b32 v44, 1, v3
    v_lshlrev_b32 v44, 6, v44
    v_add_u32 v9, v9, v44
    v_lshlrev_b32 v44, 2, v2
    v_add_u32 v9, v9, v44
    s_lshl_b32 s10, s11, 11
    s_lshl_b32 s12, s71, 10
    s_add_u32 s10, s10, s12
    s_add_u32 s10, s10, 90112
    v_add_u32 v60, s10, v9
    s_lshl_b32 s10, s3, 8
    s_add_u32 s10, s10, 90112
    v_lshlrev_b32 v9, 2, v1
    v_add_u32 v61, s10, v9
    s_lshr_b32 s10, s3, 1
    s_lshl_b32 s10, s10, 5
    s_lshl_b32 s12, s84, 2
    s_add_u32 s10, s10, s12
    s_add_u32 s10, s10, s72
    s_lshl_b32 s10, s10, 12
    s_lshl_b32 s12, s73, 10
    s_add_u32 s10, s10, s12
    s_and_b32 s12, s3, 1
    s_lshl_b32 s12, s12, 9
    s_add_u32 s10, s10, s12
    s_add_u32 s74, s10, 557056
    v_mov_b32 v63, s8
    s_mov_b32 s67, 0
    v_lshlrev_b32 v62, 4, v3
    s_lshl_b32 s10, s71, 6
    s_add_u32 s10, s10, 118784
    v_add_u32 v62, s10, v62
    s_cmp_lt_u32 s3, 4
    s_cbranch_scc1 L_A_k
L_wf_14:
    ds_read_b32 v40, v11 offset:80
    s_waitcnt lgkmcnt(0)
    v_cmp_ne_u32 vcc, 1, v40
    s_cbranch_vccnz L_wf_14
    ds_read_b64_tr_b16 v[64:65], v24
    ds_read_b64_tr_b16 v[66:67], v24 offset:1024
    ds_read_b64_tr_b16 v[68:69], v25
    ds_read_b64_tr_b16 v[70:71], v25 offset:1024
    ds_read_b64_tr_b16 v[72:73], v26
    ds_read_b64_tr_b16 v[74:75], v26 offset:1024
    ds_read_b64_tr_b16 v[76:77], v27
    ds_read_b64_tr_b16 v[78:79], v27 offset:1024
    s_waitcnt lgkmcnt(0)
    ds_read_b64_tr_b16 v[80:81], v28
    ds_read_b64_tr_b16 v[82:83], v28 offset:1024
    ds_read_b64_tr_b16 v[84:85], v29
    ds_read_b64_tr_b16 v[86:87], v29 offset:1024
    ds_read_b64_tr_b16 v[88:89], v30
    ds_read_b64_tr_b16 v[90:91], v30 offset:1024
    ds_read_b64_tr_b16 v[92:93], v31
    ds_read_b64_tr_b16 v[94:95], v31 offset:1024
L_wr_15:
    ds_read_b32 v40, v7 offset:112
    s_waitcnt lgkmcnt(0)
    v_cmp_ne_u32 vcc, 1, v40
    s_cbranch_vccnz L_wr_15
    ds_read_b128 v[48:51], v62
    s_branch L_og2_17
L_A_k:
    s_waitcnt vmcnt(0)
    ds_write_b32 v11, v0 offset:80
    s_setprio 3
    ds_read_b64_tr_b16 v[64:65], v24
    ds_read_b64_tr_b16 v[66:67], v24 offset:1024
    ds_read_b64_tr_b16 v[68:69], v25
    ds_read_b64_tr_b16 v[70:71], v25 offset:1024
    ds_read_b64_tr_b16 v[72:73], v26
    ds_read_b64_tr_b16 v[74:75], v26 offset:1024
    ds_read_b64_tr_b16 v[76:77], v27
    ds_read_b64_tr_b16 v[78:79], v27 offset:1024
    s_waitcnt lgkmcnt(0)
    ds_read_b64_tr_b16 v[80:81], v28
    ds_read_b64_tr_b16 v[82:83], v28 offset:1024
    ds_read_b64_tr_b16 v[84:85], v29
    ds_read_b64_tr_b16 v[86:87], v29 offset:1024
    ds_read_b64_tr_b16 v[88:89], v30
    ds_read_b64_tr_b16 v[90:91], v30 offset:1024
    ds_read_b64_tr_b16 v[92:93], v31
    ds_read_b64_tr_b16 v[94:95], v31 offset:1024
L_wr_18:
    ds_read_b32 v40, v7 offset:112
    s_waitcnt lgkmcnt(0)
    v_cmp_ne_u32 vcc, 1, v40
    s_cbranch_vccnz L_wr_18
    ds_read_b128 v[48:51], v62
L_wf_19:
    s_sleep 1
    ds_read_b128 v[40:43], v7 offset:96
    s_waitcnt lgkmcnt(0)
    v_and_b32 v40, v40, v41
    v_and_b32 v42, v42, v43
    v_and_b32 v40, v40, v42
    v_cmp_ne_u32 vcc, 1, v40
    s_cbranch_vccnz L_wf_19
L_og_16:
    buffer_load_dwordx4 v[192:195], v21, s[56:59], s75 offen sc1
    buffer_load_dwordx4 v[196:199], v21, s[56:59], s75 offen offset:16 sc1
L_og2_17:
    s_waitcnt vmcnt(0) lgkmcnt(0)
    v_xor_b32 v44, s8, v193
    v_xor_b32 v40, s8, v195
    v_or_b32 v40, v40, v44
    v_xor_b32 v44, s8, v197
    v_xor_b32 v45, s8, v199
    v_or3_b32 v40, v40, v44, v45
    v_cmp_ne_u32 vcc, 0, v40
    s_cbranch_vccz L_pd_20
    s_mov_b64 exec, vcc
    s_sleep 1
    s_add_u32 s67, s67, 1
    s_cmp_lt_u32 s67, 20000
    s_cbranch_scc1 L_og_16
L_pd_20:
    s_mov_b64 exec, -1
    v_mov_b32 v193, v194
    v_mov_b32 v194, v196
    v_mov_b32 v195, v198
    s_nop 1
    v_mfma_f32_16x16x32_bf16 v[96:99], v[192:195], v[64:67], 0
    v_mfma_f32_16x16x32_bf16 v[100:103], v[192:195], v[68:71], 0
    v_mfma_f32_16x16x32_bf16 v[104:107], v[192:195], v[72:75], 0
    v_mfma_f32_16x16x32_bf16 v[108:111], v[192:195], v[76:79], 0
    v_mfma_f32_16x16x32_bf16 v[112:115], v[192:195], v[80:83], 0
    v_mfma_f32_16x16x32_bf16 v[116:119], v[192:195], v[84:87], 0
    v_mfma_f32_16x16x32_bf16 v[120:123], v[192:195], v[88:91], 0
    v_mfma_f32_16x16x32_bf16 v[124:127], v[192:195], v[92:95], 0
    s_nop 0
    v_mul_f32 v128, v48, v96
    v_mul_f32 v129, v48, v100
    v_mul_f32 v130, v48, v104
    v_mul_f32 v131, v48, v108
    v_mul_f32 v132, v48, v112
    v_mul_f32 v133, v48, v116
    v_mul_f32 v134, v48, v120
    v_mul_f32 v135, v48, v124
    v_fmac_f32 v128, v49, v97
    v_fmac_f32 v129, v49, v101
    v_fmac_f32 v130, v49, v105
    v_fmac_f32 v131, v49, v109
    v_fmac_f32 v132, v49, v113
    v_fmac_f32 v133, v49, v117
    v_fmac_f32 v134, v49, v121
    v_fmac_f32 v135, v49, v125
    v_fmac_f32 v128, v50, v98
    v_fmac_f32 v129, v50, v102
    v_fmac_f32 v130, v50, v106
    v_fmac_f32 v131, v50, v110
    v_fmac_f32 v132, v50, v114
    v_fmac_f32 v133, v50, v118
    v_fmac_f32 v134, v50, v122
    v_fmac_f32 v135, v50, v126
    v_fmac_f32 v128, v51, v99
    v_fmac_f32 v129, v51, v103
    v_fmac_f32 v130, v51, v107
    v_fmac_f32 v131, v51, v111
    v_fmac_f32 v132, v51, v115
    v_fmac_f32 v133, v51, v119
    v_fmac_f32 v134, v51, v123
    v_fmac_f32 v135, v51, v127
    s_nop 0
    v_permlane16_swap_b32 v128, v129
    v_permlane16_swap_b32 v130, v131
    v_permlane16_swap_b32 v132, v133
    v_permlane16_swap_b32 v134, v135
    v_add_f32 v128, v128, v129
    v_add_f32 v130, v130, v131
    v_add_f32 v132, v132, v133
    v_add_f32 v134, v134, v135
    ds_write_b32 v60, v128 offset:0
    ds_write_b32 v60, v130 offset:128
    ds_write_b32 v60, v132 offset:256
    ds_write_b32 v60, v134 offset:384
    s_waitcnt lgkmcnt(0)
    s_barrier
    ds_read_b32 v40, v61 offset:0
    ds_read_b32 v41, v61 offset:2048
    ds_read_b32 v42, v61 offset:4096
    ds_read_b32 v43, v61 offset:6144
    s_waitcnt lgkmcnt(0)
    v_add_f32 v40, v40, v41
    v_add_f32 v42, v42, v43
    v_add_f32 v62, v40, v42
    buffer_store_dwordx2 v[62:63], v13, s[56:59], s74 offen sc1
    s_branch L_endrole
L_roleB:
    s_setprio 3
    s_add_u32 s96, s8, 1
    v_and_b32 v10, 31, v1
    v_lshlrev_b32 v10, 1, v10
    s_lshl_b32 s10, s9, 6
    buffer_load_ushort v16, v10, s[40:43], s10 offen
    v_lshrrev_b32 v9, 2, v2
    v_lshlrev_b32 v10, 3, v3
    v_add_u32 v9, v10, v9
    v_and_b32 v44, 3, v2
    v_lshlrev_b32 v44, 3, v44
    v_lshlrev_b32 v10, 6, v9
    v_add_u32 v10, v10, v44
    v_and_b32 v45, 1, v3
    v_lshlrev_b32 v46, 5, v45
    v_add_u32 v10, v10, v46
    s_lshl_b32 s10, s3, 12
    v_add_u32 v52, s10, v10
    v_xor_b32 v53, 32, v52
    v_lshlrev_b32 v10, 10, v9
    v_add_u32 v10, v10, v44
    v_lshrrev_b32 v46, 2, v2
    v_lshlrev_b32 v45, 2, v45
    v_or_b32 v46, v46, v45
    v_lshlrev_b32 v46, 5, v46
    v_add_u32 v10, v10, v46
    s_lshl_b32 s10, s3, 7
    v_xor_b32 v10, s10, v10
    v_add_u32 v54, 32768, v10
    v_xor_b32 v55, 32, v54
    v_xor_b32 v56, 64, v54
    v_xor_b32 v57, 96, v54
    v_and_b32 v58, 3, v2
    v_lshlrev_b32 v58, 10, v58
    v_lshlrev_b32 v9, 4, v3
    v_add_u32 v58, v58, v9
    s_lshl_b32 s10, s3, 7
    s_add_u32 s10, s10, 98304
    v_add_u32 v58, s10, v58
    v_lshlrev_b32 v59, 4, v2
    s_lshl_b32 s10, s3, 9
    s_add_u32 s10, s10, 110592
    v_add_u32 v59, s10, v59
    v_and_b32 v60, 31, v1
    v_lshlrev_b32 v60, 4, v60
    v_lshrrev_b32 v9, 5, v1
    v_lshlrev_b32 v9, 11, v9
    v_add_u32 v60, v60, v9
    v_add_u32 v60, 110592, v60
    v_and_b32 v61, 31, v1
    v_lshlrev_b32 v61, 1, v61
    v_lshrrev_b32 v9, 5, v1
    v_lshlrev_b32 v9, 7, v9
    v_add_u32 v61, v61, v9
    s_lshl_b32 s10, s3, 8
    s_add_u32 s10, s10, 114688
    v_add_u32 v61, s10, v61
    v_and_b32 v62, 3, v2
    v_lshlrev_b32 v62, 6, v62
    v_lshlrev_b32 v9, 4, v3
    v_add_u32 v62, v62, v9
    v_add_u32 v62, s10, v62
    s_lshl_b32 s10, s9, 12
    s_lshl_b32 s12, s3, 9
    s_add_u32 s10, s10, s12
    s_add_u32 s72, s10, 1081344
    s_add_u32 s73, s72, 229376
    s_add_u32 s74, s72, 458752
    s_add_u32 s75, s72, 688128
    v_mov_b32 v113, s96
    v_mov_b32 v115, s96
    v_mov_b32 v117, s96
    v_mov_b32 v119, s96
    v_mov_b32 v46, 0x3d372713
    s_lshl_b32 s10, s3, 10
    s_add_u32 s10, s10, 98304
    v_add_u32 v63, s10, v14
    v_lshlrev_b32 v10, 5, v1
    s_lshl_b32 s10, s3, 11
    s_lshl_b32 s12, s4, 13
    s_add_u32 s10, s10, s12
    s_add_u32 s66, s10, 1998848
L_wf_21:
    s_sleep 1
    ds_read_b128 v[40:43], v7 offset:80
    s_waitcnt lgkmcnt(0)
    v_and_b32 v40, v40, v41
    v_and_b32 v42, v42, v43
    v_and_b32 v40, v40, v42
    v_cmp_ne_u32 vcc, 1, v40
    s_cbranch_vccnz L_wf_21
    ds_read_b64_tr_b16 v[64:65], v52 offset:0
    ds_read_b64_tr_b16 v[66:67], v52 offset:256
    ds_read_b64_tr_b16 v[68:69], v53 offset:0
    ds_read_b64_tr_b16 v[70:71], v53 offset:256
    ds_read_b64_tr_b16 v[72:73], v52 offset:2048
    ds_read_b64_tr_b16 v[74:75], v52 offset:2304
    ds_read_b64_tr_b16 v[76:77], v53 offset:2048
    ds_read_b64_tr_b16 v[78:79], v53 offset:2304
    ds_read_b64_tr_b16 v[80:81], v54
    ds_read_b64_tr_b16 v[82:83], v54 offset:4096
    ds_read_b64_tr_b16 v[84:85], v55
    ds_read_b64_tr_b16 v[86:87], v55 offset:4096
    ds_read_b64_tr_b16 v[88:89], v56
    ds_read_b64_tr_b16 v[90:91], v56 offset:4096
    ds_read_b64_tr_b16 v[92:93], v57
    ds_read_b64_tr_b16 v[94:95], v57 offset:4096
    s_waitcnt vmcnt(0) lgkmcnt(0)
    v_lshlrev_b32 v16, 16, v16
    s_cmp_ge_u32 s3, 4
    s_cbranch_scc1 L_B_ln_done
    s_mov_b32 s67, 0
L_hg_22:
    buffer_load_dwordx4 v[192:195], v10, s[56:59], s66 offen sc1
    buffer_load_dwordx4 v[196:199], v10, s[56:59], s66 offen offset:16 sc1
    s_waitcnt vmcnt(0)
    v_xor_b32 v44, s8, v193
    v_xor_b32 v40, s8, v195
    v_or_b32 v40, v40, v44
    v_xor_b32 v44, s8, v197
    v_xor_b32 v45, s8, v199
    v_or3_b32 v40, v40, v44, v45
    v_cmp_ne_u32 vcc, 0, v40
    s_cbranch_vccz L_pd_23
    s_mov_b64 exec, vcc
    s_sleep 1
    s_add_u32 s67, s67, 1
    s_cmp_lt_u32 s67, 20000
    s_cbranch_scc1 L_hg_22
L_pd_23:
    s_mov_b64 exec, -1
    v_lshlrev_b32 v20, 16, v192
    v_and_b32 v21, s63, v192
    v_lshlrev_b32 v22, 16, v194
    v_and_b32 v23, s63, v194
    v_lshlrev_b32 v24, 16, v196
    v_and_b32 v25, s63, v196
    v_lshlrev_b32 v26, 16, v198
    v_and_b32 v27, s63, v198
    v_readfirstlane_b32 s12, v20
    s_nop 1
    v_subrev_f32 v34, s12, v20
    v_subrev_f32 v35, s12, v21
    v_add_f32 v32, v34, v35
    v_mul_f32 v33, v34, v34
    v_fmac_f32 v33, v35, v35
    v_subrev_f32 v34, s12, v22
    v_subrev_f32 v35, s12, v23
    v_add_f32 v32, v32, v34
    v_fmac_f32 v33, v34, v34
    v_add_f32 v32, v32, v35
    v_fmac_f32 v33, v35, v35
    v_subrev_f32 v34, s12, v24
    v_subrev_f32 v35, s12, v25
    v_add_f32 v32, v32, v34
    v_fmac_f32 v33, v34, v34
    v_add_f32 v32, v32, v35
    v_fmac_f32 v33, v35, v35
    v_subrev_f32 v34, s12, v26
    v_subrev_f32 v35, s12, v27
    v_add_f32 v32, v32, v34
    v_fmac_f32 v33, v34, v34
    v_add_f32 v32, v32, v35
    v_fmac_f32 v33, v35, v35
    s_nop 0
    v_add_f32_dpp v32, v32, v32 row_ror:8 row_mask:0xf bank_mask:0xf
    v_add_f32_dpp v33, v33, v33 row_ror:8 row_mask:0xf bank_mask:0xf
    s_nop 0
    v_add_f32_dpp v32, v32, v32 row_ror:4 row_mask:0xf bank_mask:0xf
    v_add_f32_dpp v33, v33, v33 row_ror:4 row_mask:0xf bank_mask:0xf
    s_nop 0
    v_add_f32_dpp v32, v32, v32 row_ror:2 row_mask:0xf bank_mask:0xf
    v_add_f32_dpp v33, v33, v33 row_ror:2 row_mask:0xf bank_mask:0xf
    s_nop 0
    v_add_f32_dpp v32, v32, v32 row_ror:1 row_mask:0xf bank_mask:0xf
    v_add_f32_dpp v33, v33, v33 row_ror:1 row_mask:0xf bank_mask:0xf
    v_mov_b32 v34, v32
    v_mov_b32 v35, v33
    s_nop 0
    v_permlane16_swap_b32 v32, v34
    v_permlane16_swap_b32 v33, v35
    v_add_f32 v32, v32, v34
    v_add_f32 v33, v33, v35
    v_mov_b32 v34, v32
    v_mov_b32 v35, v33
    s_nop 0
    v_permlane32_swap_b32 v32, v34
    v_permlane32_swap_b32 v33, v35
    v_add_f32 v32, v32, v34
    v_add_f32 v33, v33, v35
    v_mul_f32 v32, 0x3b000000, v32
    v_mul_f32 v33, 0x3b000000, v33
    v_fma_f32 v33, -v32, v32, v33
    v_add_f32 v32, s12, v32
    v_max_f32 v33, 0, v33
    v_cvt_pk_bf16_f32 v34, v32, v33
    v_and_b32 v33, s63, v34
    v_lshlrev_b32 v32, 16, v34
    v_add_f32 v33, 925353388, v33
    v_sub_f32 v20, v20, v32
    v_sub_f32 v21, v21, v32
    v_sub_f32 v22, v22, v32
    v_sub_f32 v23, v23, v32
    v_cvt_pk_bf16_f32 v33, v33, v33
    v_lshlrev_b32 v33, 16, v33
    v_sqrt_f32 v33, v33
    v_sub_f32 v24, v24, v32
    v_sub_f32 v25, v25, v32
    v_sub_f32 v26, v26, v32
    v_sub_f32 v27, v27, v32
    v_cvt_pk_bf16_f32 v33, v33, v33
    v_lshlrev_b32 v33, 16, v33
    v_rcp_f32 v33, v33
    v_cvt_pk_bf16_f32 v40, v20, v21
    v_cvt_pk_bf16_f32 v41, v22, v23
    v_cvt_pk_bf16_f32 v42, v24, v25
    v_cvt_pk_bf16_f32 v43, v26, v27
    v_lshlrev_b32 v20, 16, v40
    v_and_b32 v21, s63, v40
    v_lshlrev_b32 v22, 16, v41
    v_and_b32 v23, s63, v41
    v_lshlrev_b32 v24, 16, v42
    v_and_b32 v25, s63, v42
    v_lshlrev_b32 v26, 16, v43
    v_and_b32 v27, s63, v43
    v_mul_f32 v20, v20, v33
    v_mul_f32 v21, v21, v33
    v_mul_f32 v22, v22, v33
    v_mul_f32 v23, v23, v33
    v_mul_f32 v24, v24, v33
    v_mul_f32 v25, v25, v33
    v_mul_f32 v26, v26, v33
    v_mul_f32 v27, v27, v33
    v_cvt_pk_bf16_f32 v40, v20, v21
    v_cvt_pk_bf16_f32 v41, v22, v23
    v_cvt_pk_bf16_f32 v42, v24, v25
    v_cvt_pk_bf16_f32 v43, v26, v27
    ds_write_b128 v63, v[40:43]
    s_waitcnt lgkmcnt(0)
L_B_ln_done:
    s_barrier
    ds_read_b128 v[192:195], v58 offset:0
    ds_read_b128 v[196:199], v58 offset:64
    s_waitcnt lgkmcnt(0)
    v_mfma_f32_16x16x32_bf16 v[96:99], v[192:195], v[64:67], 0
    v_mfma_f32_16x16x32_bf16 v[100:103], v[192:195], v[68:71], 0
    v_mfma_f32_16x16x32_bf16 v[96:99], v[196:199], v[72:75], v[96:99]
    v_mfma_f32_16x16x32_bf16 v[100:103], v[196:199], v[76:79], v[100:103]
    s_nop 6
    ds_write_b128 v59, v[96:99]
    s_nop 0
    ds_write_b128 v59, v[100:103] offset:256
    s_waitcnt lgkmcnt(0)
    s_barrier
    ds_read_b128 v[192:195], v60 offset:0
    ds_read_b128 v[196:199], v60 offset:512
    ds_read_b128 v[200:203], v60 offset:1024
    ds_read_b128 v[204:207], v60 offset:1536
    s_waitcnt lgkmcnt(0)
    v_add_f32 v192, v192, v196
    v_add_f32 v200, v200, v204
    v_add_f32 v193, v193, v197
    v_add_f32 v201, v201, v205
    v_add_f32 v194, v194, v198
    v_add_f32 v202, v202, v206
    v_add_f32 v195, v195, v199
    v_add_f32 v203, v203, v207
    v_add_f32 v192, v192, v200
    v_add_f32 v193, v193, v201
    v_add_f32 v194, v194, v202
    v_add_f32 v195, v195, v203
    s_nop 0
    v_permlane32_swap_b32 v192, v194
    v_permlane32_swap_b32 v193, v195
    v_add_f32 v40, v192, v194
    v_add_f32 v41, v193, v195
    v_cvt_pk_bf16_f32 v42, v40, v41
    v_lshlrev_b32 v40, 16, v42
    v_and_b32 v41, s63, v42
    v_add_f32 v40, v40, v16
    v_add_f32 v41, v41, v16
    v_cvt_pk_bf16_f32 v42, v40, v41
    v_lshlrev_b32 v40, 16, v42
    v_and_b32 v41, s63, v42
    v_mul_f32 v42, v40, v40
    v_mul_f32 v43, v41, v41
    v_fma_f32 v42, v42, v46, 1.0
    v_fma_f32 v43, v43, v46, 1.0
    v_mul_f32 v42, v42, v40
    v_mul_f32 v43, v43, v41
    v_mul_f32 v42, 0xc0135761, v42
    v_mul_f32 v43, 0xc0135761, v43
    v_exp_f32 v42, v42
    v_exp_f32 v43, v43
    s_nop 0
    v_add_f32 v42, 1.0, v42
    v_add_f32 v43, 1.0, v43
    v_rcp_f32 v42, v42
    v_rcp_f32 v43, v43
    s_nop 0
    v_mul_f32 v40, v40, v42
    v_mul_f32 v41, v41, v43
    v_cvt_pk_bf16_f32 v40, v40, v41
    ds_write_b16 v61, v40
    ds_write_b16_d16_hi v61, v40 offset:64
    ds_read_b128 v[192:195], v62
    s_waitcnt lgkmcnt(0)
    v_mfma_f32_16x16x32_bf16 v[96:99], v[192:195], v[80:83], 0
    v_mfma_f32_16x16x32_bf16 v[100:103], v[192:195], v[84:87], 0
    v_mfma_f32_16x16x32_bf16 v[104:107], v[192:195], v[88:91], 0
    v_mfma_f32_16x16x32_bf16 v[108:111], v[192:195], v[92:95], 0
    s_nop 4
    v_mov_b32 v112, v96
    v_mov_b32 v114, v97
    v_mov_b32 v116, v98
    v_mov_b32 v118, v99
    v_mov_b32_dpp v112, v100 quad_perm:[0,1,2,3] row_mask:0x2 bank_mask:0xf
    v_mov_b32_dpp v114, v101 quad_perm:[0,1,2,3] row_mask:0x2 bank_mask:0xf
    v_mov_b32_dpp v116, v102 quad_perm:[0,1,2,3] row_mask:0x2 bank_mask:0xf
    v_mov_b32_dpp v118, v103 quad_perm:[0,1,2,3] row_mask:0x2 bank_mask:0xf
    v_mov_b32_dpp v112, v104 quad_perm:[0,1,2,3] row_mask:0x4 bank_mask:0xf
    v_mov_b32_dpp v114, v105 quad_perm:[0,1,2,3] row_mask:0x4 bank_mask:0xf
    v_mov_b32_dpp v116, v106 quad_perm:[0,1,2,3] row_mask:0x4 bank_mask:0xf
    v_mov_b32_dpp v118, v107 quad_perm:[0,1,2,3] row_mask:0x4 bank_mask:0xf
    v_mov_b32_dpp v112, v108 quad_perm:[0,1,2,3] row_mask:0x8 bank_mask:0xf
    v_mov_b32_dpp v114, v109 quad_perm:[0,1,2,3] row_mask:0x8 bank_mask:0xf
    v_mov_b32_dpp v116, v110 quad_perm:[0,1,2,3] row_mask:0x8 bank_mask:0xf
    v_mov_b32_dpp v118, v111 quad_perm:[0,1,2,3] row_mask:0x8 bank_mask:0xf
    buffer_store_dwordx2 v[112:113], v13, s[56:59], s72 offen sc1
    buffer_store_dwordx2 v[114:115], v13, s[56:59], s73 offen sc1
    buffer_store_dwordx2 v[116:117], v13, s[56:59], s74 offen sc1
    buffer_store_dwordx2 v[118:119], v13, s[56:59], s75 offen sc1
    s_branch L_endrole
L_roleC:
    s_cmp_lg_u32 s3, 7
    s_cbranch_scc1 L_fin
    s_setprio 3
    v_lshlrev_b32 v10, 12, v3
    v_lshlrev_b32 v9, 4, v2
    v_add_u32 v18, v10, v9
    s_lshl_b32 s10, s76, 17
    s_lshl_b32 s12, s62, 3
    s_add_u32 s10, s10, s12
    s_add_u32 s80, s10, 557056
    s_add_u32 s81, s80, 16384
    s_add_u32 s82, s80, 32768
    s_add_u32 s83, s80, 49152
    s_add_u32 s84, s80, 65536
    s_add_u32 s85, s80, 81920
    s_add_u32 s86, s80, 98304
    s_add_u32 s87, s80, 114688
    s_lshl_b32 s10, s76, 11
    s_lshl_b32 s12, s62, 2
    s_add_u32 s10, s10, s12
    s_add_u32 s72, s10, 1998848
    s_add_u32 s74, s72, 32768
    v_lshlrev_b32 v17, 3, v2
    v_lshlrev_b32 v9, 13, v3
    v_add_u32 v17, v17, v9
    s_mov_b32 s67, 0
L_sg_24:
    buffer_load_dwordx4 v[64:67], v18, s[56:59], s80 offen sc1
    buffer_load_dwordx4 v[68:71], v18, s[56:59], s81 offen sc1
    buffer_load_dwordx4 v[72:75], v18, s[56:59], s82 offen sc1
    buffer_load_dwordx4 v[76:79], v18, s[56:59], s83 offen sc1
    buffer_load_dwordx4 v[80:83], v18, s[56:59], s84 offen sc1
    buffer_load_dwordx4 v[84:87], v18, s[56:59], s85 offen sc1
    buffer_load_dwordx4 v[88:91], v18, s[56:59], s86 offen sc1
    buffer_load_dwordx4 v[92:95], v18, s[56:59], s87 offen sc1
    s_waitcnt vmcnt(0)
    v_xor_b32 v44, s8, v65
    v_xor_b32 v40, s8, v67
    v_or_b32 v40, v40, v44
    v_xor_b32 v44, s8, v69
    v_xor_b32 v45, s8, v71
    v_or3_b32 v40, v40, v44, v45
    v_xor_b32 v44, s8, v73
    v_xor_b32 v45, s8, v75
    v_or3_b32 v40, v40, v44, v45
    v_xor_b32 v44, s8, v77
    v_xor_b32 v45, s8, v79
    v_or3_b32 v40, v40, v44, v45
    v_xor_b32 v44, s8, v81
    v_xor_b32 v45, s8, v83
    v_or3_b32 v40, v40, v44, v45
    v_xor_b32 v44, s8, v85
    v_xor_b32 v45, s8, v87
    v_or3_b32 v40, v40, v44, v45
    v_xor_b32 v44, s8, v89
    v_xor_b32 v45, s8, v91
    v_or3_b32 v40, v40, v44, v45
    v_xor_b32 v44, s8, v93
    v_xor_b32 v45, s8, v95
    v_or3_b32 v40, v40, v44, v45
    v_cmp_ne_u32 vcc, 0, v40
    s_cbranch_vccz L_pd_25
    s_mov_b64 exec, vcc
    s_sleep 1
    s_add_u32 s67, s67, 1
    s_cmp_lt_u32 s67, 20000
    s_cbranch_scc1 L_sg_24
L_pd_25:
    s_mov_b64 exec, -1
    v_add_f32 v64, v64, v68
    v_add_f32 v66, v66, v70
    v_add_f32 v72, v72, v76
    v_add_f32 v74, v74, v78
    v_add_f32 v80, v80, v84
    v_add_f32 v82, v82, v86
    v_add_f32 v88, v88, v92
    v_add_f32 v90, v90, v94
    v_add_f32 v64, v64, v72
    v_add_f32 v66, v66, v74
    v_add_f32 v80, v80, v88
    v_add_f32 v82, v82, v90
    v_add_f32 v64, v64, v80
    v_add_f32 v66, v66, v82
    s_nop 1
    v_permlane32_swap_b32 v64, v66
    v_add_f32 v64, v64, v66
    v_mov_b32 v66, v64
    s_nop 1
    v_permlane16_swap_b32 v64, v66
    v_add_f32 v64, v64, v66
    v_mov_b32 v66, v64
    s_nop 1
    v_permlane32_swap_b32 v64, v66
    v_cvt_pk_bf16_f32 v40, v64, v66
    v_lshlrev_b32 v43, 16, v12
    v_and_b32 v44, s63, v12
    v_lshlrev_b32 v41, 16, v40
    v_and_b32 v42, s63, v40
    v_add_f32 v41, v41, v43
    v_add_f32 v42, v42, v44
    v_cvt_pk_bf16_f32 v40, v41, v42
    v_mov_b32 v41, v15
    buffer_store_dwordx2 v[40:41], v17, s[56:59], s72 offen sc1
    buffer_store_dwordx2 v[40:41], v17, s[56:59], s74 offen sc1
L_endrole:
    s_cmp_lg_u32 s3, 7
    s_cbranch_scc1 L_fin
    s_setprio 3
    s_add_u32 s96, s8, 1
    v_lshrrev_b32 v10, 2, v1
    v_lshlrev_b32 v10, 12, v10
    v_and_b32 v9, 3, v1
    v_lshlrev_b32 v17, 4, v9
    v_add_u32 v18, v10, v17
    s_mul_i32 s10, s5, 229376
    s_lshl_b32 s12, s95, 3
    s_add_u32 s10, s10, s12
    s_add_u32 s80, s10, 1081344
    s_add_u32 s81, s80, 65536
    s_add_u32 s82, s80, 131072
    s_add_u32 s83, s80, 196608
    s_lshl_b32 s10, s4, 13
    s_lshl_b32 s12, s5, 11
    s_add_u32 s10, s10, s12
    s_lshl_b32 s12, s95, 2
    s_add_u32 s10, s10, s12
    s_add_u32 s84, s10, 1998848
    v_lshlrev_b32 v19, 3, v9
    s_lshl_b32 s10, s5, 10
    s_lshl_b32 s12, s95, 1
    s_add_u32 s73, s10, s12
    v_lshlrev_b32 v16, 2, v9
    v_mov_b32 v76, 0
    v_mov_b32 v77, s96
    v_mov_b32 v78, 0
    v_mov_b32 v79, s96
    s_mov_b32 s67, 0
L_h4_26:
    buffer_load_dwordx2 v[20:21], v19, s[56:59], s84 offen sc1
    s_waitcnt vmcnt(0)
    v_xor_b32 v40, s8, v21
    v_cmp_ne_u32 vcc, 0, v40
    s_cbranch_vccz L_pd_27
    s_mov_b64 exec, vcc
    s_sleep 4
    s_add_u32 s67, s67, 1
    s_cmp_lt_u32 s67, 20000
    s_cbranch_scc1 L_h4_26
L_pd_27:
    s_mov_b64 exec, -1
    v_lshlrev_b32 v21, 16, v20
    v_and_b32 v22, s63, v20
    v_lshlrev_b32 v23, 16, v8
    v_and_b32 v24, s63, v8
    s_mov_b32 s67, 0
L_gg_28:
    buffer_load_dwordx4 v[64:67], v18, s[56:59], s80 offen sc1
    buffer_load_dwordx4 v[68:71], v18, s[56:59], s81 offen sc1
    buffer_load_dwordx4 v[72:75], v18, s[56:59], s82 offen sc1
    s_mov_b64 s[98:99], exec
    s_mov_b32 exec_hi, 0
    s_cbranch_execz L_x_29
    buffer_load_dwordx4 v[76:79], v18, s[56:59], s83 offen sc1
L_x_29:
    s_mov_b64 exec, s[98:99]
    s_waitcnt vmcnt(0)
    v_xor_b32 v44, s96, v65
    v_xor_b32 v40, s96, v67
    v_or_b32 v40, v40, v44
    v_xor_b32 v44, s96, v69
    v_xor_b32 v45, s96, v71
    v_or3_b32 v40, v40, v44, v45
    v_xor_b32 v44, s96, v73
    v_xor_b32 v45, s96, v75
    v_or3_b32 v40, v40, v44, v45
    v_xor_b32 v44, s96, v77
    v_xor_b32 v45, s96, v79
    v_or3_b32 v40, v40, v44, v45
    v_cmp_ne_u32 vcc, 0, v40
    s_cbranch_vccz L_pd_30
    s_mov_b64 exec, vcc
    s_sleep 1
    s_add_u32 s67, s67, 1
    s_cmp_lt_u32 s67, 20000
    s_cbranch_scc1 L_gg_28
L_pd_30:
    s_mov_b64 exec, -1
    v_add_f32 v64, v64, v68
    v_add_f32 v66, v66, v70
    v_add_f32 v72, v72, v76
    v_add_f32 v74, v74, v78
    v_add_f32 v64, v64, v72
    v_add_f32 v66, v66, v74
    s_nop 0
    v_add_f32_dpp v64, v64, v64 row_ror:4 row_mask:0xf bank_mask:0xf
    v_add_f32_dpp v66, v66, v66 row_ror:4 row_mask:0xf bank_mask:0xf
    s_nop 0
    v_add_f32_dpp v64, v64, v64 row_ror:8 row_mask:0xf bank_mask:0xf
    v_add_f32_dpp v66, v66, v66 row_ror:8 row_mask:0xf bank_mask:0xf
    s_nop 1
    v_permlane32_swap_b32 v64, v66
    v_add_f32 v64, v64, v66
    v_mov_b32 v66, v64
    s_nop 1
    v_permlane16_swap_b32 v64, v66
    v_add_f32 v64, v64, v66
    v_mov_b32 v66, v64
    s_nop 1
    v_permlane32_swap_b32 v64, v66
    v_cvt_pk_bf16_f32 v40, v64, v66
    v_lshlrev_b32 v41, 16, v40
    v_and_b32 v42, s63, v40
    v_add_f32 v41, v41, v23
    v_add_f32 v42, v42, v24
    v_cvt_pk_bf16_f32 v40, v41, v42
    v_lshlrev_b32 v41, 16, v40
    v_and_b32 v42, s63, v40
    v_add_f32 v41, v41, v21
    v_add_f32 v42, v42, v22
    v_cvt_pk_bf16_f32 v40, v41, v42
    s_mov_b64 exec, 0xf
    buffer_store_dword v40, v16, s[52:55], s73 offen
    s_mov_b64 exec, -1
    s_cmp_lg_u32 s2, 0
    s_cbranch_scc1 L_fin
    s_mov_b64 exec, 1
    buffer_store_dword v15, v6, s[56:59], 0 offen sc1
    s_mov_b64 exec, -1
L_fin:
L_end:
    s_endpgm
.section .rodata,"a"
.p2align 6
.amdhsa_kernel sequential_preLN__gqa_block_cached__mixer_channel_mlp__decode_kernel
  .amdhsa_next_free_vgpr 256
  .amdhsa_next_free_sgpr 102
  .amdhsa_accum_offset 256
  .amdhsa_group_segment_fixed_size 0
  .amdhsa_kernarg_size 104
  .amdhsa_user_sgpr_count 2
  .amdhsa_user_sgpr_kernarg_segment_ptr 1
  .amdhsa_system_sgpr_workgroup_id_x 1
.end_amdhsa_kernel
```
